```python
import torch

def _softmax(x, axis=-1):
    return torch.softmax(x, dim=axis)
def _gelu(x):
    return torch.nn.functional.gelu(x, approximate="tanh")
def _silu(x):
    return torch.nn.functional.silu(x)
def _sigmoid(x):
    return torch.sigmoid(x)
def _layernorm(x, axis=-1, eps=1e-5):
    m = x.mean(dim=axis, keepdim=True)
    v = x.var(dim=axis, keepdim=True, unbiased=False)
    return (x - m) / torch.sqrt(v + eps)
def _scatter_add(tgt, idx, src, axis=0):
    return tgt.clone().index_add_(axis, idx, src)
def _segment_sum(src, seg, n):
    out = torch.zeros((n,) + src.shape[1:], dtype=src.dtype)
    return out.index_add_(0, seg, src)
def _pad(x, pw):
    flat = tuple(v for pair in reversed(pw) for v in pair)
    return torch.nn.functional.pad(x, flat)

kernel_name = 'parallel_sum__ssm_conv_s4__glu_gated_bilinear__prompt'

def setup_inputs():

    _w = (lambda a: (lambda t: t.to(torch.bfloat16) if t.is_floating_point() else t)(torch.as_tensor(a)))
    def _A_setup():
        B, L, D, N = 1, 2048, 448, 256
        A_re = -(lambda _x: torch.exp(torch.as_tensor(_x)))((lambda *s: torch.randn(*s, dtype=torch.bfloat16) * 6.4)(D, N))
        A_im = torch.pi * (lambda *s: torch.randn(*s, dtype=torch.bfloat16) * 0.05)(D, N)
        B_re = (lambda *s: torch.randn(*s, dtype=torch.bfloat16) * 0.1)(D, N)
        B_im = (lambda *s: torch.randn(*s, dtype=torch.bfloat16) * 0.1)(D, N)
        C_re = (lambda *s: torch.randn(*s, dtype=torch.bfloat16) * 0.1)(D, N)
        C_im = (lambda *s: torch.randn(*s, dtype=torch.bfloat16) * 0.1)(D, N)
        log_dt = (lambda *s: torch.randn(*s, dtype=torch.bfloat16) * 0.05)(D) * 0.5 - 4.0
        Dskip = (lambda *s: torch.randn(*s, dtype=torch.bfloat16) * 0.05)(D)
        return {
            "u": _w((lambda *s: torch.randn(*s, dtype=torch.bfloat16) * 0.05)(B, L, D)),
            "A_re": _w(A_re),
            "A_im": _w(A_im),
            "B_re": _w(B_re),
            "B_im": _w(B_im),
            "C_re": _w(C_re),
            "C_im": _w(C_im),
            "log_dt": _w(log_dt),
            "Dskip": _w(Dskip),
        }
    _A_in = _A_setup()

    def _B_setup():
        B, S, D, F = 1, 2048, 448, 1792
        return {
            "x": _w((lambda *s: torch.randn(*s, dtype=torch.bfloat16) * 0.05)(B, S, D)),
            "w_gate": _w((lambda *s: torch.randn(*s, dtype=torch.bfloat16) * 0.4)(D, F) * (D ** -0.5)),
            "w_up": _w((lambda *s: torch.randn(*s, dtype=torch.bfloat16) * 0.4)(D, F) * (D ** -0.5)),
            "w_down": _w((lambda *s: torch.randn(*s, dtype=torch.bfloat16) * 0.4)(F, D) * (F ** -0.5)),
        }
    _B_in = _B_setup()

    return {
        "A_u": _A_in["u"],
        "A_A_re": _A_in["A_re"],
        "A_A_im": _A_in["A_im"],
        "A_B_re": _A_in["B_re"],
        "A_B_im": _A_in["B_im"],
        "A_C_re": _A_in["C_re"],
        "A_C_im": _A_in["C_im"],
        "A_log_dt": _A_in["log_dt"],
        "A_Dskip": _A_in["Dskip"],
        "B_x": _B_in["x"],
        "B_w_gate": _B_in["w_gate"],
        "B_w_up": _B_in["w_up"],
        "B_w_down": _B_in["w_down"],
    }

def reference(A_u, A_A_re, A_A_im, A_B_re, A_B_im, A_C_re, A_C_im, A_log_dt, A_Dskip, B_x, B_w_gate, B_w_up, B_w_down):
    def _A_ref(u, A_re, A_im, B_re, B_im, C_re, C_im, log_dt, Dskip):
        Bsz, L, D = u.shape
        dt = torch.exp(log_dt)[:, None]
        A = A_re + 1j * A_im
        Bc = B_re + 1j * B_im
        Cc = C_re + 1j * C_im
        logdA = dt * A
        dB = dt * Bc
        l = (lambda x, dt: x.to(dt))(torch.arange(L), A_re.dtype)
        P = torch.exp(logdA[:, :, None] * l[None, None, :])
        K = torch.einsum("dn,dnl,dn->dl", Cc, P, dB).real
        L2 = 2 * L
        Kp = _pad(K, ((0, 0), (0, L)))
        up = (lambda x, *d: x.permute(*d))(u, 0, 2, 1)
        up = _pad(up, ((0, 0), (0, 0), (0, L)))
        Kf = (lambda x, axes=(-2,-1): torch.fft.rfft2(x.float(), dim=axes))(Kp[:, None, :], axes=(-2, -1))
        Uf = (lambda x, axes=(-2,-1): torch.fft.rfft2(x.float(), dim=axes))(up[:, :, None, :], axes=(-2, -1))
        Yf = Uf * Kf[None, :, :, :]
        y = (lambda x, s, axes=(-2,-1): torch.fft.irfft2(x, s=s, dim=axes).to(torch.bfloat16))(Yf, (1, L2), axes=(-2, -1))[:, :, 0, :L]
        y = (lambda x, *d: x.permute(*d))(y, 0, 2, 1) + u * Dskip[None, None, :]
        return y

    def _B_ref(x, w_gate, w_up, w_down):
        g = torch.einsum("bsd,df->bsf", x, w_gate)
        u = torch.einsum("bsd,df->bsf", x, w_up)
        h = g * u
        return torch.einsum("bsf,fd->bsd", h, w_down)

    x = A_u
    xn = _layernorm(x, axis=-1)
    return x + _A_ref(xn, A_A_re, A_A_im, A_B_re, A_B_im, A_C_re, A_C_im, A_log_dt, A_Dskip) + _B_ref(xn, B_w_gate, B_w_up, B_w_down)
```

```asm
; @launch kernel=prep_kernel grid=(659,1,1) block=(256,1,1) lds=16384
; @launch kernel=mid_kernel grid=(448,1,1) block=(512,1,1) lds=65536
; @launch kernel=fin_kernel grid=(224,1,1) block=(512,1,1) lds=139264
.amdgcn_target "amdgcn-amd-amdhsa--gfx950"
.text
.globl prep_kernel
.p2align 8
.type prep_kernel,@function
prep_kernel:
    s_load_dwordx16 s[16:31], s[0:1], 0
    s_load_dwordx16 s[32:47], s[0:1], 64
    v_lshrrev_b32 v1, 6, v0
    s_nop 0
    v_readfirstlane_b32 s3, v1
    v_and_b32 v1, 63, v0
    s_waitcnt lgkmcnt(0)
    s_mov_b32 s8, s46
    s_and_b32 s9, s47, 0xffff
    s_mov_b32 s10, 0x1694000
    s_mov_b32 s11, 0x20000
    s_cmp_lt_u32 s2, 64
    s_cbranch_scc1 L_ln
    s_cmp_lt_u32 s2, 211
    s_cbranch_scc1 L_rel
    s_cmp_lt_u32 s2, 659
    s_cbranch_scc1 L_kgen
L_p_end:
    s_endpgm
L_ln:
    v_and_b32 v2, 31, v1
    v_lshrrev_b32 v3, 5, v1
    v_mul_u32_u24 v4, 896, v2
    v_lshl_add_u32 v4, v3, 4, v4
    s_mul_i32 s4, s2, 28672
    s_mul_i32 s5, s3, 224
    s_add_u32 s4, s4, s5
    v_add_u32 v4, s4, v4
    global_load_dwordx4 v[10:13], v4, s[16:17] offset:0
    global_load_dwordx4 v[14:17], v4, s[16:17] offset:32
    global_load_dwordx4 v[18:21], v4, s[16:17] offset:64
    global_load_dwordx4 v[22:25], v4, s[16:17] offset:96
    global_load_dwordx4 v[26:29], v4, s[16:17] offset:128
    global_load_dwordx4 v[30:33], v4, s[16:17] offset:160
    global_load_dwordx4 v[34:37], v4, s[16:17] offset:192
    v_lshlrev_b32 v5, 2, v0
    v_lshlrev_b32 v6, 2, v2
    s_waitcnt vmcnt(6)
    v_lshlrev_b32 v40, 16, v10
    v_and_b32 v41, 0xffff0000, v10
    v_lshlrev_b32 v42, 16, v11
    v_and_b32 v43, 0xffff0000, v11
    v_lshlrev_b32 v44, 16, v12
    v_and_b32 v45, 0xffff0000, v12
    v_lshlrev_b32 v46, 16, v13
    v_and_b32 v47, 0xffff0000, v13
    s_waitcnt vmcnt(5)
    v_lshlrev_b32 v48, 16, v14
    v_and_b32 v49, 0xffff0000, v14
    v_lshlrev_b32 v50, 16, v15
    v_and_b32 v51, 0xffff0000, v15
    v_lshlrev_b32 v52, 16, v16
    v_and_b32 v53, 0xffff0000, v16
    v_lshlrev_b32 v54, 16, v17
    v_and_b32 v55, 0xffff0000, v17
    s_waitcnt vmcnt(4)
    v_lshlrev_b32 v56, 16, v18
    v_and_b32 v57, 0xffff0000, v18
    v_lshlrev_b32 v58, 16, v19
    v_and_b32 v59, 0xffff0000, v19
    v_lshlrev_b32 v60, 16, v20
    v_and_b32 v61, 0xffff0000, v20
    v_lshlrev_b32 v62, 16, v21
    v_and_b32 v63, 0xffff0000, v21
    s_waitcnt vmcnt(3)
    v_lshlrev_b32 v64, 16, v22
    v_and_b32 v65, 0xffff0000, v22
    v_lshlrev_b32 v66, 16, v23
    v_and_b32 v67, 0xffff0000, v23
    v_lshlrev_b32 v68, 16, v24
    v_and_b32 v69, 0xffff0000, v24
    v_lshlrev_b32 v70, 16, v25
    v_and_b32 v71, 0xffff0000, v25
    s_waitcnt vmcnt(2)
    v_lshlrev_b32 v72, 16, v26
    v_and_b32 v73, 0xffff0000, v26
    v_lshlrev_b32 v74, 16, v27
    v_and_b32 v75, 0xffff0000, v27
    v_lshlrev_b32 v76, 16, v28
    v_and_b32 v77, 0xffff0000, v28
    v_lshlrev_b32 v78, 16, v29
    v_and_b32 v79, 0xffff0000, v29
    s_waitcnt vmcnt(1)
    v_lshlrev_b32 v80, 16, v30
    v_and_b32 v81, 0xffff0000, v30
    v_lshlrev_b32 v82, 16, v31
    v_and_b32 v83, 0xffff0000, v31
    v_lshlrev_b32 v84, 16, v32
    v_and_b32 v85, 0xffff0000, v32
    v_lshlrev_b32 v86, 16, v33
    v_and_b32 v87, 0xffff0000, v33
    s_waitcnt vmcnt(0)
    v_lshlrev_b32 v88, 16, v34
    v_and_b32 v89, 0xffff0000, v34
    v_lshlrev_b32 v90, 16, v35
    v_and_b32 v91, 0xffff0000, v35
    v_lshlrev_b32 v92, 16, v36
    v_and_b32 v93, 0xffff0000, v36
    v_lshlrev_b32 v94, 16, v37
    v_and_b32 v95, 0xffff0000, v37
    v_add_f32 v96, v40, v44
    v_add_f32 v97, v41, v45
    v_add_f32 v98, v42, v46
    v_add_f32 v99, v43, v47
    v_add_f32 v96, v96, v48
    v_add_f32 v97, v97, v49
    v_add_f32 v98, v98, v50
    v_add_f32 v99, v99, v51
    v_add_f32 v96, v96, v52
    v_add_f32 v97, v97, v53
    v_add_f32 v98, v98, v54
    v_add_f32 v99, v99, v55
    v_add_f32 v96, v96, v56
    v_add_f32 v97, v97, v57
    v_add_f32 v98, v98, v58
    v_add_f32 v99, v99, v59
    v_add_f32 v96, v96, v60
    v_add_f32 v97, v97, v61
    v_add_f32 v98, v98, v62
    v_add_f32 v99, v99, v63
    v_add_f32 v96, v96, v64
    v_add_f32 v97, v97, v65
    v_add_f32 v98, v98, v66
    v_add_f32 v99, v99, v67
    v_add_f32 v96, v96, v68
    v_add_f32 v97, v97, v69
    v_add_f32 v98, v98, v70
    v_add_f32 v99, v99, v71
    v_add_f32 v96, v96, v72
    v_add_f32 v97, v97, v73
    v_add_f32 v98, v98, v74
    v_add_f32 v99, v99, v75
    v_add_f32 v96, v96, v76
    v_add_f32 v97, v97, v77
    v_add_f32 v98, v98, v78
    v_add_f32 v99, v99, v79
    v_add_f32 v96, v96, v80
    v_add_f32 v97, v97, v81
    v_add_f32 v98, v98, v82
    v_add_f32 v99, v99, v83
    v_add_f32 v96, v96, v84
    v_add_f32 v97, v97, v85
    v_add_f32 v98, v98, v86
    v_add_f32 v99, v99, v87
    v_add_f32 v96, v96, v88
    v_add_f32 v97, v97, v89
    v_add_f32 v98, v98, v90
    v_add_f32 v99, v99, v91
    v_add_f32 v96, v96, v92
    v_add_f32 v97, v97, v93
    v_add_f32 v98, v98, v94
    v_add_f32 v99, v99, v95
    v_add_f32 v96, v96, v97
    v_add_f32 v98, v98, v99
    v_add_f32 v96, v96, v98
    ds_write_b32 v5, v96
    s_waitcnt lgkmcnt(0)
    s_barrier
    ds_read2_b32 v[100:101], v6 offset0:0 offset1:32
    ds_read2_b32 v[102:103], v6 offset0:64 offset1:96
    ds_read2_b32 v[104:105], v6 offset0:128 offset1:160
    ds_read2_b32 v[106:107], v6 offset0:192 offset1:224
    s_waitcnt lgkmcnt(0)
    v_add_f32 v100, v100, v101
    v_add_f32 v102, v102, v103
    v_add_f32 v104, v104, v105
    v_add_f32 v106, v106, v107
    v_add_f32 v100, v100, v102
    v_add_f32 v104, v104, v106
    v_add_f32 v100, v100, v104
    v_mul_f32 v7, 0x3b124925, v100
    v_sub_f32 v108, v40, v7
    v_sub_f32 v109, v41, v7
    v_sub_f32 v110, v42, v7
    v_sub_f32 v111, v43, v7
    v_mul_f32 v96, v108, v108
    v_mul_f32 v97, v109, v109
    v_mul_f32 v98, v110, v110
    v_mul_f32 v99, v111, v111
    v_sub_f32 v108, v44, v7
    v_sub_f32 v109, v45, v7
    v_sub_f32 v110, v46, v7
    v_sub_f32 v111, v47, v7
    v_fmac_f32 v96, v108, v108
    v_fmac_f32 v97, v109, v109
    v_fmac_f32 v98, v110, v110
    v_fmac_f32 v99, v111, v111
    v_sub_f32 v108, v48, v7
    v_sub_f32 v109, v49, v7
    v_sub_f32 v110, v50, v7
    v_sub_f32 v111, v51, v7
    v_fmac_f32 v96, v108, v108
    v_fmac_f32 v97, v109, v109
    v_fmac_f32 v98, v110, v110
    v_fmac_f32 v99, v111, v111
    v_sub_f32 v108, v52, v7
    v_sub_f32 v109, v53, v7
    v_sub_f32 v110, v54, v7
    v_sub_f32 v111, v55, v7
    v_fmac_f32 v96, v108, v108
    v_fmac_f32 v97, v109, v109
    v_fmac_f32 v98, v110, v110
    v_fmac_f32 v99, v111, v111
    v_sub_f32 v108, v56, v7
    v_sub_f32 v109, v57, v7
    v_sub_f32 v110, v58, v7
    v_sub_f32 v111, v59, v7
    v_fmac_f32 v96, v108, v108
    v_fmac_f32 v97, v109, v109
    v_fmac_f32 v98, v110, v110
    v_fmac_f32 v99, v111, v111
    v_sub_f32 v108, v60, v7
    v_sub_f32 v109, v61, v7
    v_sub_f32 v110, v62, v7
    v_sub_f32 v111, v63, v7
    v_fmac_f32 v96, v108, v108
    v_fmac_f32 v97, v109, v109
    v_fmac_f32 v98, v110, v110
    v_fmac_f32 v99, v111, v111
    v_sub_f32 v108, v64, v7
    v_sub_f32 v109, v65, v7
    v_sub_f32 v110, v66, v7
    v_sub_f32 v111, v67, v7
    v_fmac_f32 v96, v108, v108
    v_fmac_f32 v97, v109, v109
    v_fmac_f32 v98, v110, v110
    v_fmac_f32 v99, v111, v111
    v_sub_f32 v108, v68, v7
    v_sub_f32 v109, v69, v7
    v_sub_f32 v110, v70, v7
    v_sub_f32 v111, v71, v7
    v_fmac_f32 v96, v108, v108
    v_fmac_f32 v97, v109, v109
    v_fmac_f32 v98, v110, v110
    v_fmac_f32 v99, v111, v111
    v_sub_f32 v108, v72, v7
    v_sub_f32 v109, v73, v7
    v_sub_f32 v110, v74, v7
    v_sub_f32 v111, v75, v7
    v_fmac_f32 v96, v108, v108
    v_fmac_f32 v97, v109, v109
    v_fmac_f32 v98, v110, v110
    v_fmac_f32 v99, v111, v111
    v_sub_f32 v108, v76, v7
    v_sub_f32 v109, v77, v7
    v_sub_f32 v110, v78, v7
    v_sub_f32 v111, v79, v7
    v_fmac_f32 v96, v108, v108
    v_fmac_f32 v97, v109, v109
    v_fmac_f32 v98, v110, v110
    v_fmac_f32 v99, v111, v111
    v_sub_f32 v108, v80, v7
    v_sub_f32 v109, v81, v7
    v_sub_f32 v110, v82, v7
    v_sub_f32 v111, v83, v7
    v_fmac_f32 v96, v108, v108
    v_fmac_f32 v97, v109, v109
    v_fmac_f32 v98, v110, v110
    v_fmac_f32 v99, v111, v111
    v_sub_f32 v108, v84, v7
    v_sub_f32 v109, v85, v7
    v_sub_f32 v110, v86, v7
    v_sub_f32 v111, v87, v7
    v_fmac_f32 v96, v108, v108
    v_fmac_f32 v97, v109, v109
    v_fmac_f32 v98, v110, v110
    v_fmac_f32 v99, v111, v111
    v_sub_f32 v108, v88, v7
    v_sub_f32 v109, v89, v7
    v_sub_f32 v110, v90, v7
    v_sub_f32 v111, v91, v7
    v_fmac_f32 v96, v108, v108
    v_fmac_f32 v97, v109, v109
    v_fmac_f32 v98, v110, v110
    v_fmac_f32 v99, v111, v111
    v_sub_f32 v108, v92, v7
    v_sub_f32 v109, v93, v7
    v_sub_f32 v110, v94, v7
    v_sub_f32 v111, v95, v7
    v_fmac_f32 v96, v108, v108
    v_fmac_f32 v97, v109, v109
    v_fmac_f32 v98, v110, v110
    v_fmac_f32 v99, v111, v111
    v_add_f32 v96, v96, v97
    v_add_f32 v98, v98, v99
    v_add_f32 v96, v96, v98
    ds_write_b32 v5, v96 offset:1024
    s_waitcnt lgkmcnt(0)
    s_barrier
    v_add_u32 v8, 1024, v6
    ds_read2_b32 v[100:101], v8 offset0:0 offset1:32
    ds_read2_b32 v[102:103], v8 offset0:64 offset1:96
    ds_read2_b32 v[104:105], v8 offset0:128 offset1:160
    ds_read2_b32 v[106:107], v8 offset0:192 offset1:224
    s_waitcnt lgkmcnt(0)
    v_add_f32 v100, v100, v101
    v_add_f32 v102, v102, v103
    v_add_f32 v104, v104, v105
    v_add_f32 v106, v106, v107
    v_add_f32 v100, v100, v102
    v_add_f32 v104, v104, v106
    v_add_f32 v100, v100, v104
    v_mul_f32 v100, 0x3b124925, v100
    v_cvt_pk_bf16_f32 v101, v7, v100
    v_lshlrev_b32 v7, 16, v101
    v_and_b32 v100, 0xffff0000, v101
    v_add_f32 v100, 0x3727c5ac, v100
    v_cvt_pk_bf16_f32 v100, v100, v100
    v_lshlrev_b32 v100, 16, v100
    v_sqrt_f32 v100, v100
    s_nop 0
    v_cvt_pk_bf16_f32 v100, v100, v100
    v_lshlrev_b32 v8, 16, v100
    v_rcp_f32 v9, v8
    s_nop 0
    s_cmp_lg_u32 s3, 0
    s_cbranch_scc1 L_ln_nostat
    s_mov_b64 exec, 0xffffffff
    v_lshlrev_b32 v100, 3, v2
    s_lshl_b32 s4, s2, 8
    s_add_u32 s4, s4, 0x548000
    v_mov_b32 v102, v7
    v_mov_b32 v103, v8
    buffer_store_dwordx2 v[102:103], v100, s[8:11], s4 offen sc1
    s_mov_b64 exec, -1
L_ln_nostat:
    v_sub_f32 v40, v40, v7
    v_sub_f32 v41, v41, v7
    v_sub_f32 v42, v42, v7
    v_sub_f32 v43, v43, v7
    v_sub_f32 v44, v44, v7
    v_sub_f32 v45, v45, v7
    v_sub_f32 v46, v46, v7
    v_sub_f32 v47, v47, v7
    v_cvt_pk_bf16_f32 v100, v40, v41
    v_cvt_pk_bf16_f32 v101, v42, v43
    v_cvt_pk_bf16_f32 v102, v44, v45
    v_cvt_pk_bf16_f32 v103, v46, v47
    v_lshlrev_b32 v40, 16, v100
    v_and_b32 v41, 0xffff0000, v100
    v_lshlrev_b32 v42, 16, v101
    v_and_b32 v43, 0xffff0000, v101
    v_lshlrev_b32 v44, 16, v102
    v_and_b32 v45, 0xffff0000, v102
    v_lshlrev_b32 v46, 16, v103
    v_and_b32 v47, 0xffff0000, v103
    v_mul_f32 v104, v40, v9
    v_mul_f32 v105, v41, v9
    v_mul_f32 v106, v42, v9
    v_mul_f32 v107, v43, v9
    v_mul_f32 v108, v44, v9
    v_mul_f32 v109, v45, v9
    v_mul_f32 v110, v46, v9
    v_mul_f32 v111, v47, v9
    v_fma_f32 v40, -v104, v8, v40
    v_fma_f32 v41, -v105, v8, v41
    v_fma_f32 v42, -v106, v8, v42
    v_fma_f32 v43, -v107, v8, v43
    v_fma_f32 v44, -v108, v8, v44
    v_fma_f32 v45, -v109, v8, v45
    v_fma_f32 v46, -v110, v8, v46
    v_fma_f32 v47, -v111, v8, v47
    v_fmac_f32 v104, v40, v9
    v_fmac_f32 v105, v41, v9
    v_fmac_f32 v106, v42, v9
    v_fmac_f32 v107, v43, v9
    v_fmac_f32 v108, v44, v9
    v_fmac_f32 v109, v45, v9
    v_fmac_f32 v110, v46, v9
    v_fmac_f32 v111, v47, v9
    v_cvt_pk_bf16_f32 v10, v104, v105
    v_cvt_pk_bf16_f32 v11, v106, v107
    v_cvt_pk_bf16_f32 v12, v108, v109
    v_cvt_pk_bf16_f32 v13, v110, v111
    v_sub_f32 v48, v48, v7
    v_sub_f32 v49, v49, v7
    v_sub_f32 v50, v50, v7
    v_sub_f32 v51, v51, v7
    v_sub_f32 v52, v52, v7
    v_sub_f32 v53, v53, v7
    v_sub_f32 v54, v54, v7
    v_sub_f32 v55, v55, v7
    v_cvt_pk_bf16_f32 v100, v48, v49
    v_cvt_pk_bf16_f32 v101, v50, v51
    v_cvt_pk_bf16_f32 v102, v52, v53
    v_cvt_pk_bf16_f32 v103, v54, v55
    v_lshlrev_b32 v48, 16, v100
    v_and_b32 v49, 0xffff0000, v100
    v_lshlrev_b32 v50, 16, v101
    v_and_b32 v51, 0xffff0000, v101
    v_lshlrev_b32 v52, 16, v102
    v_and_b32 v53, 0xffff0000, v102
    v_lshlrev_b32 v54, 16, v103
    v_and_b32 v55, 0xffff0000, v103
    v_mul_f32 v104, v48, v9
    v_mul_f32 v105, v49, v9
    v_mul_f32 v106, v50, v9
    v_mul_f32 v107, v51, v9
    v_mul_f32 v108, v52, v9
    v_mul_f32 v109, v53, v9
    v_mul_f32 v110, v54, v9
    v_mul_f32 v111, v55, v9
    v_fma_f32 v48, -v104, v8, v48
    v_fma_f32 v49, -v105, v8, v49
    v_fma_f32 v50, -v106, v8, v50
    v_fma_f32 v51, -v107, v8, v51
    v_fma_f32 v52, -v108, v8, v52
    v_fma_f32 v53, -v109, v8, v53
    v_fma_f32 v54, -v110, v8, v54
    v_fma_f32 v55, -v111, v8, v55
    v_fmac_f32 v104, v48, v9
    v_fmac_f32 v105, v49, v9
    v_fmac_f32 v106, v50, v9
    v_fmac_f32 v107, v51, v9
    v_fmac_f32 v108, v52, v9
    v_fmac_f32 v109, v53, v9
    v_fmac_f32 v110, v54, v9
    v_fmac_f32 v111, v55, v9
    v_cvt_pk_bf16_f32 v14, v104, v105
    v_cvt_pk_bf16_f32 v15, v106, v107
    v_cvt_pk_bf16_f32 v16, v108, v109
    v_cvt_pk_bf16_f32 v17, v110, v111
    v_sub_f32 v56, v56, v7
    v_sub_f32 v57, v57, v7
    v_sub_f32 v58, v58, v7
    v_sub_f32 v59, v59, v7
    v_sub_f32 v60, v60, v7
    v_sub_f32 v61, v61, v7
    v_sub_f32 v62, v62, v7
    v_sub_f32 v63, v63, v7
    v_cvt_pk_bf16_f32 v100, v56, v57
    v_cvt_pk_bf16_f32 v101, v58, v59
    v_cvt_pk_bf16_f32 v102, v60, v61
    v_cvt_pk_bf16_f32 v103, v62, v63
    v_lshlrev_b32 v56, 16, v100
    v_and_b32 v57, 0xffff0000, v100
    v_lshlrev_b32 v58, 16, v101
    v_and_b32 v59, 0xffff0000, v101
    v_lshlrev_b32 v60, 16, v102
    v_and_b32 v61, 0xffff0000, v102
    v_lshlrev_b32 v62, 16, v103
    v_and_b32 v63, 0xffff0000, v103
    v_mul_f32 v104, v56, v9
    v_mul_f32 v105, v57, v9
    v_mul_f32 v106, v58, v9
    v_mul_f32 v107, v59, v9
    v_mul_f32 v108, v60, v9
    v_mul_f32 v109, v61, v9
    v_mul_f32 v110, v62, v9
    v_mul_f32 v111, v63, v9
    v_fma_f32 v56, -v104, v8, v56
    v_fma_f32 v57, -v105, v8, v57
    v_fma_f32 v58, -v106, v8, v58
    v_fma_f32 v59, -v107, v8, v59
    v_fma_f32 v60, -v108, v8, v60
    v_fma_f32 v61, -v109, v8, v61
    v_fma_f32 v62, -v110, v8, v62
    v_fma_f32 v63, -v111, v8, v63
    v_fmac_f32 v104, v56, v9
    v_fmac_f32 v105, v57, v9
    v_fmac_f32 v106, v58, v9
    v_fmac_f32 v107, v59, v9
    v_fmac_f32 v108, v60, v9
    v_fmac_f32 v109, v61, v9
    v_fmac_f32 v110, v62, v9
    v_fmac_f32 v111, v63, v9
    v_cvt_pk_bf16_f32 v18, v104, v105
    v_cvt_pk_bf16_f32 v19, v106, v107
    v_cvt_pk_bf16_f32 v20, v108, v109
    v_cvt_pk_bf16_f32 v21, v110, v111
    v_sub_f32 v64, v64, v7
    v_sub_f32 v65, v65, v7
    v_sub_f32 v66, v66, v7
    v_sub_f32 v67, v67, v7
    v_sub_f32 v68, v68, v7
    v_sub_f32 v69, v69, v7
    v_sub_f32 v70, v70, v7
    v_sub_f32 v71, v71, v7
    v_cvt_pk_bf16_f32 v100, v64, v65
    v_cvt_pk_bf16_f32 v101, v66, v67
    v_cvt_pk_bf16_f32 v102, v68, v69
    v_cvt_pk_bf16_f32 v103, v70, v71
    v_lshlrev_b32 v64, 16, v100
    v_and_b32 v65, 0xffff0000, v100
    v_lshlrev_b32 v66, 16, v101
    v_and_b32 v67, 0xffff0000, v101
    v_lshlrev_b32 v68, 16, v102
    v_and_b32 v69, 0xffff0000, v102
    v_lshlrev_b32 v70, 16, v103
    v_and_b32 v71, 0xffff0000, v103
    v_mul_f32 v104, v64, v9
    v_mul_f32 v105, v65, v9
    v_mul_f32 v106, v66, v9
    v_mul_f32 v107, v67, v9
    v_mul_f32 v108, v68, v9
    v_mul_f32 v109, v69, v9
    v_mul_f32 v110, v70, v9
    v_mul_f32 v111, v71, v9
    v_fma_f32 v64, -v104, v8, v64
    v_fma_f32 v65, -v105, v8, v65
    v_fma_f32 v66, -v106, v8, v66
    v_fma_f32 v67, -v107, v8, v67
    v_fma_f32 v68, -v108, v8, v68
    v_fma_f32 v69, -v109, v8, v69
    v_fma_f32 v70, -v110, v8, v70
    v_fma_f32 v71, -v111, v8, v71
    v_fmac_f32 v104, v64, v9
    v_fmac_f32 v105, v65, v9
    v_fmac_f32 v106, v66, v9
    v_fmac_f32 v107, v67, v9
    v_fmac_f32 v108, v68, v9
    v_fmac_f32 v109, v69, v9
    v_fmac_f32 v110, v70, v9
    v_fmac_f32 v111, v71, v9
    v_cvt_pk_bf16_f32 v22, v104, v105
    v_cvt_pk_bf16_f32 v23, v106, v107
    v_cvt_pk_bf16_f32 v24, v108, v109
    v_cvt_pk_bf16_f32 v25, v110, v111
    v_sub_f32 v72, v72, v7
    v_sub_f32 v73, v73, v7
    v_sub_f32 v74, v74, v7
    v_sub_f32 v75, v75, v7
    v_sub_f32 v76, v76, v7
    v_sub_f32 v77, v77, v7
    v_sub_f32 v78, v78, v7
    v_sub_f32 v79, v79, v7
    v_cvt_pk_bf16_f32 v100, v72, v73
    v_cvt_pk_bf16_f32 v101, v74, v75
    v_cvt_pk_bf16_f32 v102, v76, v77
    v_cvt_pk_bf16_f32 v103, v78, v79
    v_lshlrev_b32 v72, 16, v100
    v_and_b32 v73, 0xffff0000, v100
    v_lshlrev_b32 v74, 16, v101
    v_and_b32 v75, 0xffff0000, v101
    v_lshlrev_b32 v76, 16, v102
    v_and_b32 v77, 0xffff0000, v102
    v_lshlrev_b32 v78, 16, v103
    v_and_b32 v79, 0xffff0000, v103
    v_mul_f32 v104, v72, v9
    v_mul_f32 v105, v73, v9
    v_mul_f32 v106, v74, v9
    v_mul_f32 v107, v75, v9
    v_mul_f32 v108, v76, v9
    v_mul_f32 v109, v77, v9
    v_mul_f32 v110, v78, v9
    v_mul_f32 v111, v79, v9
    v_fma_f32 v72, -v104, v8, v72
    v_fma_f32 v73, -v105, v8, v73
    v_fma_f32 v74, -v106, v8, v74
    v_fma_f32 v75, -v107, v8, v75
    v_fma_f32 v76, -v108, v8, v76
    v_fma_f32 v77, -v109, v8, v77
    v_fma_f32 v78, -v110, v8, v78
    v_fma_f32 v79, -v111, v8, v79
    v_fmac_f32 v104, v72, v9
    v_fmac_f32 v105, v73, v9
    v_fmac_f32 v106, v74, v9
    v_fmac_f32 v107, v75, v9
    v_fmac_f32 v108, v76, v9
    v_fmac_f32 v109, v77, v9
    v_fmac_f32 v110, v78, v9
    v_fmac_f32 v111, v79, v9
    v_cvt_pk_bf16_f32 v26, v104, v105
    v_cvt_pk_bf16_f32 v27, v106, v107
    v_cvt_pk_bf16_f32 v28, v108, v109
    v_cvt_pk_bf16_f32 v29, v110, v111
    v_sub_f32 v80, v80, v7
    v_sub_f32 v81, v81, v7
    v_sub_f32 v82, v82, v7
    v_sub_f32 v83, v83, v7
    v_sub_f32 v84, v84, v7
    v_sub_f32 v85, v85, v7
    v_sub_f32 v86, v86, v7
    v_sub_f32 v87, v87, v7
    v_cvt_pk_bf16_f32 v100, v80, v81
    v_cvt_pk_bf16_f32 v101, v82, v83
    v_cvt_pk_bf16_f32 v102, v84, v85
    v_cvt_pk_bf16_f32 v103, v86, v87
    v_lshlrev_b32 v80, 16, v100
    v_and_b32 v81, 0xffff0000, v100
    v_lshlrev_b32 v82, 16, v101
    v_and_b32 v83, 0xffff0000, v101
    v_lshlrev_b32 v84, 16, v102
    v_and_b32 v85, 0xffff0000, v102
    v_lshlrev_b32 v86, 16, v103
    v_and_b32 v87, 0xffff0000, v103
    v_mul_f32 v104, v80, v9
    v_mul_f32 v105, v81, v9
    v_mul_f32 v106, v82, v9
    v_mul_f32 v107, v83, v9
    v_mul_f32 v108, v84, v9
    v_mul_f32 v109, v85, v9
    v_mul_f32 v110, v86, v9
    v_mul_f32 v111, v87, v9
    v_fma_f32 v80, -v104, v8, v80
    v_fma_f32 v81, -v105, v8, v81
    v_fma_f32 v82, -v106, v8, v82
    v_fma_f32 v83, -v107, v8, v83
    v_fma_f32 v84, -v108, v8, v84
    v_fma_f32 v85, -v109, v8, v85
    v_fma_f32 v86, -v110, v8, v86
    v_fma_f32 v87, -v111, v8, v87
    v_fmac_f32 v104, v80, v9
    v_fmac_f32 v105, v81, v9
    v_fmac_f32 v106, v82, v9
    v_fmac_f32 v107, v83, v9
    v_fmac_f32 v108, v84, v9
    v_fmac_f32 v109, v85, v9
    v_fmac_f32 v110, v86, v9
    v_fmac_f32 v111, v87, v9
    v_cvt_pk_bf16_f32 v30, v104, v105
    v_cvt_pk_bf16_f32 v31, v106, v107
    v_cvt_pk_bf16_f32 v32, v108, v109
    v_cvt_pk_bf16_f32 v33, v110, v111
    v_sub_f32 v88, v88, v7
    v_sub_f32 v89, v89, v7
    v_sub_f32 v90, v90, v7
    v_sub_f32 v91, v91, v7
    v_sub_f32 v92, v92, v7
    v_sub_f32 v93, v93, v7
    v_sub_f32 v94, v94, v7
    v_sub_f32 v95, v95, v7
    v_cvt_pk_bf16_f32 v100, v88, v89
    v_cvt_pk_bf16_f32 v101, v90, v91
    v_cvt_pk_bf16_f32 v102, v92, v93
    v_cvt_pk_bf16_f32 v103, v94, v95
    v_lshlrev_b32 v88, 16, v100
    v_and_b32 v89, 0xffff0000, v100
    v_lshlrev_b32 v90, 16, v101
    v_and_b32 v91, 0xffff0000, v101
    v_lshlrev_b32 v92, 16, v102
    v_and_b32 v93, 0xffff0000, v102
    v_lshlrev_b32 v94, 16, v103
    v_and_b32 v95, 0xffff0000, v103
    v_mul_f32 v104, v88, v9
    v_mul_f32 v105, v89, v9
    v_mul_f32 v106, v90, v9
    v_mul_f32 v107, v91, v9
    v_mul_f32 v108, v92, v9
    v_mul_f32 v109, v93, v9
    v_mul_f32 v110, v94, v9
    v_mul_f32 v111, v95, v9
    v_fma_f32 v88, -v104, v8, v88
    v_fma_f32 v89, -v105, v8, v89
    v_fma_f32 v90, -v106, v8, v90
    v_fma_f32 v91, -v107, v8, v91
    v_fma_f32 v92, -v108, v8, v92
    v_fma_f32 v93, -v109, v8, v93
    v_fma_f32 v94, -v110, v8, v94
    v_fma_f32 v95, -v111, v8, v95
    v_fmac_f32 v104, v88, v9
    v_fmac_f32 v105, v89, v9
    v_fmac_f32 v106, v90, v9
    v_fmac_f32 v107, v91, v9
    v_fmac_f32 v108, v92, v9
    v_fmac_f32 v109, v93, v9
    v_fmac_f32 v110, v94, v9
    v_fmac_f32 v111, v95, v9
    v_cvt_pk_bf16_f32 v34, v104, v105
    v_cvt_pk_bf16_f32 v35, v106, v107
    v_cvt_pk_bf16_f32 v36, v108, v109
    v_cvt_pk_bf16_f32 v37, v110, v111
    v_lshlrev_b32 v4, 4, v1
    s_mul_i32 s4, s2, 28
    s_mul_i32 s5, s3, 7
    s_add_u32 s4, s4, s5
    s_lshl_b32 s4, s4, 10
    s_add_u32 s5, s4, 4096
    buffer_store_dwordx4 v[10:13], v4, s[8:11], s4 offen offset:0 sc1
    buffer_store_dwordx4 v[14:17], v4, s[8:11], s4 offen offset:1024 sc1
    buffer_store_dwordx4 v[18:21], v4, s[8:11], s4 offen offset:2048 sc1
    buffer_store_dwordx4 v[22:25], v4, s[8:11], s4 offen offset:3072 sc1
    buffer_store_dwordx4 v[26:29], v4, s[8:11], s5 offen offset:0 sc1
    buffer_store_dwordx4 v[30:33], v4, s[8:11], s5 offen offset:1024 sc1
    buffer_store_dwordx4 v[34:37], v4, s[8:11], s5 offen offset:2048 sc1
    s_endpgm
L_rel:
    s_sub_u32 s4, s2, 64
    s_lshl_b32 s4, s4, 2
    s_add_u32 s4, s4, s3
    v_and_b32 v2, 31, v1
    v_lshrrev_b32 v3, 5, v1
    v_lshlrev_b32 v4, 4, v1
    s_cmp_ge_u32 s4, 392
    s_cbranch_scc1 L_rel_wd
    s_mov_b32 s48, s36
    s_and_b32 s49, s37, 0xffff
    s_mov_b32 s50, 0x188000
    s_mov_b32 s51, 0x20000
    s_mov_b32 s52, s38
    s_and_b32 s53, s39, 0xffff
    s_mov_b32 s54, 0x188000
    s_mov_b32 s55, 0x20000
    s_mul_i32 s5, s4, 9363
    s_lshr_b32 s5, s5, 16
    s_mul_i32 s6, s5, 7
    s_sub_u32 s6, s4, s6
    s_mul_i32 s6, s6, 229376
    s_lshl_b32 s5, s5, 6
    s_add_u32 s6, s6, s5
    v_mul_u32_u24 v5, 28672, v3
    v_lshl_add_u32 v5, v2, 1, v5
    s_lshl_b32 s7, s4, 13
    s_add_u32 s7, s7, 0x54c000
    buffer_load_ushort v32, v5, s[48:51], s6 offen
    buffer_load_ushort v40, v5, s[52:55], s6 offen
    s_add_u32 s6, s6, 3584
    buffer_load_ushort v33, v5, s[48:51], s6 offen
    buffer_load_ushort v41, v5, s[52:55], s6 offen
    s_add_u32 s6, s6, 3584
    buffer_load_ushort v34, v5, s[48:51], s6 offen
    buffer_load_ushort v42, v5, s[52:55], s6 offen
    s_add_u32 s6, s6, 3584
    buffer_load_ushort v35, v5, s[48:51], s6 offen
    buffer_load_ushort v43, v5, s[52:55], s6 offen
    s_add_u32 s6, s6, 3584
    buffer_load_ushort v36, v5, s[48:51], s6 offen
    buffer_load_ushort v44, v5, s[52:55], s6 offen
    s_add_u32 s6, s6, 3584
    buffer_load_ushort v37, v5, s[48:51], s6 offen
    buffer_load_ushort v45, v5, s[52:55], s6 offen
    s_add_u32 s6, s6, 3584
    buffer_load_ushort v38, v5, s[48:51], s6 offen
    buffer_load_ushort v46, v5, s[52:55], s6 offen
    s_add_u32 s6, s6, 3584
    buffer_load_ushort v39, v5, s[48:51], s6 offen
    buffer_load_ushort v47, v5, s[52:55], s6 offen
    s_add_u32 s6, s6, 32256
    buffer_load_ushort v48, v5, s[48:51], s6 offen
    buffer_load_ushort v56, v5, s[52:55], s6 offen
    s_add_u32 s6, s6, 3584
    buffer_load_ushort v49, v5, s[48:51], s6 offen
    buffer_load_ushort v57, v5, s[52:55], s6 offen
    s_add_u32 s6, s6, 3584
    buffer_load_ushort v50, v5, s[48:51], s6 offen
    buffer_load_ushort v58, v5, s[52:55], s6 offen
    s_add_u32 s6, s6, 3584
    buffer_load_ushort v51, v5, s[48:51], s6 offen
    buffer_load_ushort v59, v5, s[52:55], s6 offen
    s_add_u32 s6, s6, 3584
    buffer_load_ushort v52, v5, s[48:51], s6 offen
    buffer_load_ushort v60, v5, s[52:55], s6 offen
    s_add_u32 s6, s6, 3584
    buffer_load_ushort v53, v5, s[48:51], s6 offen
    buffer_load_ushort v61, v5, s[52:55], s6 offen
    s_add_u32 s6, s6, 3584
    buffer_load_ushort v54, v5, s[48:51], s6 offen
    buffer_load_ushort v62, v5, s[52:55], s6 offen
    s_add_u32 s6, s6, 3584
    buffer_load_ushort v55, v5, s[48:51], s6 offen
    buffer_load_ushort v63, v5, s[52:55], s6 offen
    s_add_u32 s6, s6, 32256
    s_waitcnt vmcnt(0)
    v_lshl_or_b32 v10, v33, 16, v32
    v_lshl_or_b32 v11, v35, 16, v34
    v_lshl_or_b32 v12, v37, 16, v36
    v_lshl_or_b32 v13, v39, 16, v38
    v_lshl_or_b32 v14, v41, 16, v40
    v_lshl_or_b32 v15, v43, 16, v42
    v_lshl_or_b32 v16, v45, 16, v44
    v_lshl_or_b32 v17, v47, 16, v46
    v_lshl_or_b32 v18, v49, 16, v48
    v_lshl_or_b32 v19, v51, 16, v50
    v_lshl_or_b32 v20, v53, 16, v52
    v_lshl_or_b32 v21, v55, 16, v54
    v_lshl_or_b32 v22, v57, 16, v56
    v_lshl_or_b32 v23, v59, 16, v58
    v_lshl_or_b32 v24, v61, 16, v60
    v_lshl_or_b32 v25, v63, 16, v62
    buffer_store_dwordx4 v[10:13], v4, s[8:11], s7 offen offset:0 sc1
    buffer_store_dwordx4 v[14:17], v4, s[8:11], s7 offen offset:1024 sc1
    buffer_store_dwordx4 v[18:21], v4, s[8:11], s7 offen offset:2048 sc1
    buffer_store_dwordx4 v[22:25], v4, s[8:11], s7 offen offset:3072 sc1
    s_add_u32 s7, s7, 4096
    s_nop 1
    buffer_load_ushort v32, v5, s[48:51], s6 offen
    buffer_load_ushort v40, v5, s[52:55], s6 offen
    s_add_u32 s6, s6, 3584
    buffer_load_ushort v33, v5, s[48:51], s6 offen
    buffer_load_ushort v41, v5, s[52:55], s6 offen
    s_add_u32 s6, s6, 3584
    buffer_load_ushort v34, v5, s[48:51], s6 offen
    buffer_load_ushort v42, v5, s[52:55], s6 offen
    s_add_u32 s6, s6, 3584
    buffer_load_ushort v35, v5, s[48:51], s6 offen
    buffer_load_ushort v43, v5, s[52:55], s6 offen
    s_add_u32 s6, s6, 3584
    buffer_load_ushort v36, v5, s[48:51], s6 offen
    buffer_load_ushort v44, v5, s[52:55], s6 offen
    s_add_u32 s6, s6, 3584
    buffer_load_ushort v37, v5, s[48:51], s6 offen
    buffer_load_ushort v45, v5, s[52:55], s6 offen
    s_add_u32 s6, s6, 3584
    buffer_load_ushort v38, v5, s[48:51], s6 offen
    buffer_load_ushort v46, v5, s[52:55], s6 offen
    s_add_u32 s6, s6, 3584
    buffer_load_ushort v39, v5, s[48:51], s6 offen
    buffer_load_ushort v47, v5, s[52:55], s6 offen
    s_add_u32 s6, s6, 32256
    buffer_load_ushort v48, v5, s[48:51], s6 offen
    buffer_load_ushort v56, v5, s[52:55], s6 offen
    s_add_u32 s6, s6, 3584
    buffer_load_ushort v49, v5, s[48:51], s6 offen
    buffer_load_ushort v57, v5, s[52:55], s6 offen
    s_add_u32 s6, s6, 3584
    buffer_load_ushort v50, v5, s[48:51], s6 offen
    buffer_load_ushort v58, v5, s[52:55], s6 offen
    s_add_u32 s6, s6, 3584
    buffer_load_ushort v51, v5, s[48:51], s6 offen
    buffer_load_ushort v59, v5, s[52:55], s6 offen
    s_add_u32 s6, s6, 3584
    buffer_load_ushort v52, v5, s[48:51], s6 offen
    buffer_load_ushort v60, v5, s[52:55], s6 offen
    s_add_u32 s6, s6, 3584
    buffer_load_ushort v53, v5, s[48:51], s6 offen
    buffer_load_ushort v61, v5, s[52:55], s6 offen
    s_add_u32 s6, s6, 3584
    buffer_load_ushort v54, v5, s[48:51], s6 offen
    buffer_load_ushort v62, v5, s[52:55], s6 offen
    s_add_u32 s6, s6, 3584
    buffer_load_ushort v55, v5, s[48:51], s6 offen
    buffer_load_ushort v63, v5, s[52:55], s6 offen
    s_add_u32 s6, s6, 32256
    s_waitcnt vmcnt(0)
    v_lshl_or_b32 v10, v33, 16, v32
    v_lshl_or_b32 v11, v35, 16, v34
    v_lshl_or_b32 v12, v37, 16, v36
    v_lshl_or_b32 v13, v39, 16, v38
    v_lshl_or_b32 v14, v41, 16, v40
    v_lshl_or_b32 v15, v43, 16, v42
    v_lshl_or_b32 v16, v45, 16, v44
    v_lshl_or_b32 v17, v47, 16, v46
    v_lshl_or_b32 v18, v49, 16, v48
    v_lshl_or_b32 v19, v51, 16, v50
    v_lshl_or_b32 v20, v53, 16, v52
    v_lshl_or_b32 v21, v55, 16, v54
    v_lshl_or_b32 v22, v57, 16, v56
    v_lshl_or_b32 v23, v59, 16, v58
    v_lshl_or_b32 v24, v61, 16, v60
    v_lshl_or_b32 v25, v63, 16, v62
    buffer_store_dwordx4 v[10:13], v4, s[8:11], s7 offen offset:0 sc1
    buffer_store_dwordx4 v[14:17], v4, s[8:11], s7 offen offset:1024 sc1
    buffer_store_dwordx4 v[18:21], v4, s[8:11], s7 offen offset:2048 sc1
    buffer_store_dwordx4 v[22:25], v4, s[8:11], s7 offen offset:3072 sc1
    s_endpgm
L_rel_wd:
    s_mov_b32 s48, s40
    s_and_b32 s49, s41, 0xffff
    s_mov_b32 s50, 0x188000
    s_mov_b32 s51, 0x20000
    s_sub_u32 s4, s4, 392
    s_mul_i32 s5, s4, 4682
    s_lshr_b32 s5, s5, 16
    s_mul_i32 s6, s5, 14
    s_sub_u32 s6, s4, s6
    s_mul_i32 s6, s6, 114688
    s_lshl_b32 s5, s5, 6
    s_add_u32 s6, s6, s5
    v_mul_u32_u24 v5, 3584, v3
    v_lshl_add_u32 v5, v2, 1, v5
    s_lshl_b32 s7, s4, 13
    s_add_u32 s7, s7, 0x85c000
    buffer_load_ushort v32, v5, s[48:51], s6 offen offset:0
    buffer_load_ushort v33, v5, s[48:51], s6 offen offset:896
    buffer_load_ushort v34, v5, s[48:51], s6 offen offset:1792
    buffer_load_ushort v35, v5, s[48:51], s6 offen offset:2688
    s_add_u32 s6, s6, 7168
    buffer_load_ushort v36, v5, s[48:51], s6 offen offset:0
    buffer_load_ushort v37, v5, s[48:51], s6 offen offset:896
    buffer_load_ushort v38, v5, s[48:51], s6 offen offset:1792
    buffer_load_ushort v39, v5, s[48:51], s6 offen offset:2688
    s_add_u32 s6, s6, 7168
    buffer_load_ushort v40, v5, s[48:51], s6 offen offset:0
    buffer_load_ushort v41, v5, s[48:51], s6 offen offset:896
    buffer_load_ushort v42, v5, s[48:51], s6 offen offset:1792
    buffer_load_ushort v43, v5, s[48:51], s6 offen offset:2688
    s_add_u32 s6, s6, 7168
    buffer_load_ushort v44, v5, s[48:51], s6 offen offset:0
    buffer_load_ushort v45, v5, s[48:51], s6 offen offset:896
    buffer_load_ushort v46, v5, s[48:51], s6 offen offset:1792
    buffer_load_ushort v47, v5, s[48:51], s6 offen offset:2688
    s_add_u32 s6, s6, 7168
    buffer_load_ushort v48, v5, s[48:51], s6 offen offset:0
    buffer_load_ushort v49, v5, s[48:51], s6 offen offset:896
    buffer_load_ushort v50, v5, s[48:51], s6 offen offset:1792
    buffer_load_ushort v51, v5, s[48:51], s6 offen offset:2688
    s_add_u32 s6, s6, 7168
    buffer_load_ushort v52, v5, s[48:51], s6 offen offset:0
    buffer_load_ushort v53, v5, s[48:51], s6 offen offset:896
    buffer_load_ushort v54, v5, s[48:51], s6 offen offset:1792
    buffer_load_ushort v55, v5, s[48:51], s6 offen offset:2688
    s_add_u32 s6, s6, 7168
    buffer_load_ushort v56, v5, s[48:51], s6 offen offset:0
    buffer_load_ushort v57, v5, s[48:51], s6 offen offset:896
    buffer_load_ushort v58, v5, s[48:51], s6 offen offset:1792
    buffer_load_ushort v59, v5, s[48:51], s6 offen offset:2688
    s_add_u32 s6, s6, 7168
    buffer_load_ushort v60, v5, s[48:51], s6 offen offset:0
    buffer_load_ushort v61, v5, s[48:51], s6 offen offset:896
    buffer_load_ushort v62, v5, s[48:51], s6 offen offset:1792
    buffer_load_ushort v63, v5, s[48:51], s6 offen offset:2688
    s_add_u32 s6, s6, 7168
    s_waitcnt vmcnt(0)
    v_lshl_or_b32 v10, v33, 16, v32
    v_lshl_or_b32 v11, v35, 16, v34
    v_lshl_or_b32 v12, v37, 16, v36
    v_lshl_or_b32 v13, v39, 16, v38
    v_lshl_or_b32 v14, v41, 16, v40
    v_lshl_or_b32 v15, v43, 16, v42
    v_lshl_or_b32 v16, v45, 16, v44
    v_lshl_or_b32 v17, v47, 16, v46
    v_lshl_or_b32 v18, v49, 16, v48
    v_lshl_or_b32 v19, v51, 16, v50
    v_lshl_or_b32 v20, v53, 16, v52
    v_lshl_or_b32 v21, v55, 16, v54
    v_lshl_or_b32 v22, v57, 16, v56
    v_lshl_or_b32 v23, v59, 16, v58
    v_lshl_or_b32 v24, v61, 16, v60
    v_lshl_or_b32 v25, v63, 16, v62
    buffer_store_dwordx4 v[10:13], v4, s[8:11], s7 offen offset:0 sc1
    buffer_store_dwordx4 v[14:17], v4, s[8:11], s7 offen offset:1024 sc1
    buffer_store_dwordx4 v[18:21], v4, s[8:11], s7 offen offset:2048 sc1
    buffer_store_dwordx4 v[22:25], v4, s[8:11], s7 offen offset:3072 sc1
    s_add_u32 s7, s7, 4096
    s_nop 1
    buffer_load_ushort v32, v5, s[48:51], s6 offen offset:0
    buffer_load_ushort v33, v5, s[48:51], s6 offen offset:896
    buffer_load_ushort v34, v5, s[48:51], s6 offen offset:1792
    buffer_load_ushort v35, v5, s[48:51], s6 offen offset:2688
    s_add_u32 s6, s6, 7168
    buffer_load_ushort v36, v5, s[48:51], s6 offen offset:0
    buffer_load_ushort v37, v5, s[48:51], s6 offen offset:896
    buffer_load_ushort v38, v5, s[48:51], s6 offen offset:1792
    buffer_load_ushort v39, v5, s[48:51], s6 offen offset:2688
    s_add_u32 s6, s6, 7168
    buffer_load_ushort v40, v5, s[48:51], s6 offen offset:0
    buffer_load_ushort v41, v5, s[48:51], s6 offen offset:896
    buffer_load_ushort v42, v5, s[48:51], s6 offen offset:1792
    buffer_load_ushort v43, v5, s[48:51], s6 offen offset:2688
    s_add_u32 s6, s6, 7168
    buffer_load_ushort v44, v5, s[48:51], s6 offen offset:0
    buffer_load_ushort v45, v5, s[48:51], s6 offen offset:896
    buffer_load_ushort v46, v5, s[48:51], s6 offen offset:1792
    buffer_load_ushort v47, v5, s[48:51], s6 offen offset:2688
    s_add_u32 s6, s6, 7168
    buffer_load_ushort v48, v5, s[48:51], s6 offen offset:0
    buffer_load_ushort v49, v5, s[48:51], s6 offen offset:896
    buffer_load_ushort v50, v5, s[48:51], s6 offen offset:1792
    buffer_load_ushort v51, v5, s[48:51], s6 offen offset:2688
    s_add_u32 s6, s6, 7168
    buffer_load_ushort v52, v5, s[48:51], s6 offen offset:0
    buffer_load_ushort v53, v5, s[48:51], s6 offen offset:896
    buffer_load_ushort v54, v5, s[48:51], s6 offen offset:1792
    buffer_load_ushort v55, v5, s[48:51], s6 offen offset:2688
    s_add_u32 s6, s6, 7168
    buffer_load_ushort v56, v5, s[48:51], s6 offen offset:0
    buffer_load_ushort v57, v5, s[48:51], s6 offen offset:896
    buffer_load_ushort v58, v5, s[48:51], s6 offen offset:1792
    buffer_load_ushort v59, v5, s[48:51], s6 offen offset:2688
    s_add_u32 s6, s6, 7168
    buffer_load_ushort v60, v5, s[48:51], s6 offen offset:0
    buffer_load_ushort v61, v5, s[48:51], s6 offen offset:896
    buffer_load_ushort v62, v5, s[48:51], s6 offen offset:1792
    buffer_load_ushort v63, v5, s[48:51], s6 offen offset:2688
    s_add_u32 s6, s6, 7168
    s_waitcnt vmcnt(0)
    v_lshl_or_b32 v10, v33, 16, v32
    v_lshl_or_b32 v11, v35, 16, v34
    v_lshl_or_b32 v12, v37, 16, v36
    v_lshl_or_b32 v13, v39, 16, v38
    v_lshl_or_b32 v14, v41, 16, v40
    v_lshl_or_b32 v15, v43, 16, v42
    v_lshl_or_b32 v16, v45, 16, v44
    v_lshl_or_b32 v17, v47, 16, v46
    v_lshl_or_b32 v18, v49, 16, v48
    v_lshl_or_b32 v19, v51, 16, v50
    v_lshl_or_b32 v20, v53, 16, v52
    v_lshl_or_b32 v21, v55, 16, v54
    v_lshl_or_b32 v22, v57, 16, v56
    v_lshl_or_b32 v23, v59, 16, v58
    v_lshl_or_b32 v24, v61, 16, v60
    v_lshl_or_b32 v25, v63, 16, v62
    buffer_store_dwordx4 v[10:13], v4, s[8:11], s7 offen offset:0 sc1
    buffer_store_dwordx4 v[14:17], v4, s[8:11], s7 offen offset:1024 sc1
    buffer_store_dwordx4 v[18:21], v4, s[8:11], s7 offen offset:2048 sc1
    buffer_store_dwordx4 v[22:25], v4, s[8:11], s7 offen offset:3072 sc1
    s_endpgm
L_kgen:
    s_sub_u32 s4, s2, 211
    s_lshr_b32 s5, s4, 1
    s_lshl_b32 s5, s5, 2
    s_load_dword s6, s[30:31], s5
    v_and_b32 v2, 15, v1
    v_lshrrev_b32 v3, 4, v1
    s_lshl_b32 s5, s4, 9
    v_lshlrev_b32 v11, 1, v0
    v_add_u32 v11, s5, v11
    global_load_ushort v24, v11, s[18:19]
    global_load_ushort v25, v11, s[20:21]
    global_load_ushort v26, v11, s[22:23]
    global_load_ushort v27, v11, s[24:25]
    global_load_ushort v28, v11, s[26:27]
    global_load_ushort v29, v11, s[28:29]
    v_lshrrev_b32 v88, 3, v2
    v_and_b32 v89, 7, v2
    v_lshl_add_u32 v88, v88, 7, v89
    v_cvt_f32_u32 v4, v88
    v_lshrrev_b32 v88, 2, v2
    v_and_b32 v89, 3, v2
    v_lshlrev_b32 v89, 1, v89
    v_lshl_add_u32 v88, v88, 7, v89
    v_add_u32 v88, 256, v88
    v_subrev_u32 v90, 8, v2
    v_lshrrev_b32 v90, 1, v90
    v_and_b32 v91, 1, v2
    v_lshlrev_b32 v91, 2, v91
    v_lshl_add_u32 v90, v90, 7, v91
    v_add_u32 v90, 512, v90
    v_cmp_gt_u32 vcc, 8, v2
    s_nop 1
    v_cndmask_b32 v88, v90, v88, vcc
    v_cvt_f32_u32 v5, v88
    v_lshlrev_b32 v88, 7, v2
    v_add_u32 v88, 1024, v88
    v_cmp_gt_u32 vcc, 9, v2
    s_nop 1
    v_cndmask_b32 v88, 0, v88, vcc
    v_cvt_f32_u32 v6, v88
    v_lshlrev_b32 v88, 3, v2
    v_cvt_f32_u32 v7, v88
    v_mov_b32 v12, 0
    v_mov_b32 v13, 0
    v_mov_b32 v14, 0
    v_mov_b32 v15, 0
    v_mov_b32 v16, 0
    v_mov_b32 v17, 0
    v_mov_b32 v18, 0
    v_mov_b32 v19, 0
    v_mov_b32 v20, 0
    v_mov_b32 v21, 0
    v_mov_b32 v22, 0
    v_mov_b32 v23, 0
    v_lshlrev_b32 v30, 3, v0
    v_sub_u32 v30, 2047, v30
    v_subrev_u32 v32, 0, v30
    v_subrev_u32 v33, 1, v30
    v_subrev_u32 v34, 2, v30
    v_subrev_u32 v35, 3, v30
    v_subrev_u32 v36, 4, v30
    v_subrev_u32 v37, 5, v30
    v_subrev_u32 v38, 6, v30
    v_subrev_u32 v39, 7, v30
    v_cvt_f32_u32 v32, v32
    v_cvt_f32_u32 v33, v33
    v_cvt_f32_u32 v34, v34
    v_cvt_f32_u32 v35, v35
    v_cvt_f32_u32 v36, v36
    v_cvt_f32_u32 v37, v37
    v_cvt_f32_u32 v38, v38
    v_cvt_f32_u32 v39, v39
    v_cvt_pk_bf16_f32 v32, v32, v32
    v_cvt_pk_bf16_f32 v33, v33, v33
    v_cvt_pk_bf16_f32 v34, v34, v34
    v_cvt_pk_bf16_f32 v35, v35, v35
    v_cvt_pk_bf16_f32 v36, v36, v36
    v_cvt_pk_bf16_f32 v37, v37, v37
    v_cvt_pk_bf16_f32 v38, v38, v38
    v_cvt_pk_bf16_f32 v39, v39, v39
    v_lshlrev_b32 v32, 16, v32
    v_lshlrev_b32 v33, 16, v33
    v_lshlrev_b32 v34, 16, v34
    v_lshlrev_b32 v35, 16, v35
    v_lshlrev_b32 v36, 16, v36
    v_lshlrev_b32 v37, 16, v37
    v_lshlrev_b32 v38, 16, v38
    v_lshlrev_b32 v39, 16, v39
    v_bfe_u32 v40, v32, 23, 8
    v_bfe_u32 v41, v33, 23, 8
    v_bfe_u32 v42, v34, 23, 8
    v_bfe_u32 v43, v35, 23, 8
    v_bfe_u32 v44, v36, 23, 8
    v_bfe_u32 v45, v37, 23, 8
    v_bfe_u32 v46, v38, 23, 8
    v_bfe_u32 v47, v39, 23, 8
    v_cvt_u32_f32 v32, v32
    v_cvt_u32_f32 v33, v33
    v_cvt_u32_f32 v34, v34
    v_cvt_u32_f32 v35, v35
    v_cvt_u32_f32 v36, v36
    v_cvt_u32_f32 v37, v37
    v_cvt_u32_f32 v38, v38
    v_cvt_u32_f32 v39, v39
    v_subrev_u32 v40, 134, v40
    v_subrev_u32 v41, 134, v41
    v_subrev_u32 v42, 134, v42
    v_subrev_u32 v43, 134, v43
    v_subrev_u32 v44, 134, v44
    v_subrev_u32 v45, 134, v45
    v_subrev_u32 v46, 134, v46
    v_subrev_u32 v47, 134, v47
    v_med3_i32 v40, v40, 0, 3
    v_med3_i32 v41, v41, 0, 3
    v_med3_i32 v42, v42, 0, 3
    v_med3_i32 v43, v43, 0, 3
    v_med3_i32 v44, v44, 0, 3
    v_med3_i32 v45, v45, 0, 3
    v_med3_i32 v46, v46, 0, 3
    v_med3_i32 v47, v47, 0, 3
    v_lshrrev_b32 v48, 7, v32
    v_lshrrev_b32 v49, 7, v33
    v_lshrrev_b32 v50, 7, v34
    v_lshrrev_b32 v51, 7, v35
    v_lshrrev_b32 v52, 7, v36
    v_lshrrev_b32 v53, 7, v37
    v_lshrrev_b32 v54, 7, v38
    v_lshrrev_b32 v55, 7, v39
    v_sub_u32 v56, 3, v40
    v_sub_u32 v57, 3, v41
    v_sub_u32 v58, 3, v42
    v_sub_u32 v59, 3, v43
    v_sub_u32 v60, 3, v44
    v_sub_u32 v61, 3, v45
    v_sub_u32 v62, 3, v46
    v_sub_u32 v63, 3, v47
    v_lshlrev_b32 v48, v56, v48
    v_lshlrev_b32 v49, v57, v49
    v_lshlrev_b32 v50, v58, v50
    v_lshlrev_b32 v51, v59, v51
    v_lshlrev_b32 v52, v60, v52
    v_lshlrev_b32 v53, v61, v53
    v_lshlrev_b32 v54, v62, v54
    v_lshlrev_b32 v55, v63, v55
    v_and_b32 v56, 7, v32
    v_and_b32 v57, 7, v33
    v_and_b32 v58, 7, v34
    v_and_b32 v59, 7, v35
    v_and_b32 v60, 7, v36
    v_and_b32 v61, 7, v37
    v_and_b32 v62, 7, v38
    v_and_b32 v63, 7, v39
    v_lshrrev_b32 v56, v40, v56
    v_lshrrev_b32 v57, v41, v57
    v_lshrrev_b32 v58, v42, v58
    v_lshrrev_b32 v59, v43, v59
    v_lshrrev_b32 v60, v44, v60
    v_lshrrev_b32 v61, v45, v61
    v_lshrrev_b32 v62, v46, v62
    v_lshrrev_b32 v63, v47, v63
    v_lshl_add_u32 v48, v40, 3, v48
    v_lshl_add_u32 v49, v41, 3, v49
    v_lshl_add_u32 v50, v42, 3, v50
    v_lshl_add_u32 v51, v43, 3, v51
    v_lshl_add_u32 v52, v44, 3, v52
    v_lshl_add_u32 v53, v45, 3, v53
    v_lshl_add_u32 v54, v46, 3, v54
    v_lshl_add_u32 v55, v47, 3, v55
    v_add_u32 v48, v48, v56
    v_add_u32 v49, v49, v57
    v_add_u32 v50, v50, v58
    v_add_u32 v51, v51, v59
    v_add_u32 v52, v52, v60
    v_add_u32 v53, v53, v61
    v_add_u32 v54, v54, v62
    v_add_u32 v55, v55, v63
    v_bfe_u32 v56, v32, 3, 4
    v_bfe_u32 v57, v33, 3, 4
    v_bfe_u32 v58, v34, 3, 4
    v_bfe_u32 v59, v35, 3, 4
    v_bfe_u32 v60, v36, 3, 4
    v_bfe_u32 v61, v37, 3, 4
    v_bfe_u32 v62, v38, 3, 4
    v_bfe_u32 v63, v39, 3, 4
    v_lshl_add_u32 v48, v48, 4, v56
    v_lshl_add_u32 v49, v49, 4, v57
    v_lshl_add_u32 v50, v50, 4, v58
    v_lshl_add_u32 v51, v51, 4, v59
    v_lshl_add_u32 v52, v52, 4, v60
    v_lshl_add_u32 v53, v53, 4, v61
    v_lshl_add_u32 v54, v54, 4, v62
    v_lshl_add_u32 v55, v55, 4, v63
    v_lshlrev_b32 v110, 2, v48
    v_lshlrev_b32 v111, 2, v49
    v_lshlrev_b32 v112, 2, v50
    v_lshlrev_b32 v113, 2, v51
    v_lshlrev_b32 v114, 2, v52
    v_lshlrev_b32 v115, 2, v53
    v_lshlrev_b32 v116, 2, v54
    v_lshlrev_b32 v117, 2, v55
    s_waitcnt lgkmcnt(0)
    s_and_b32 s5, s4, 1
    s_lshl_b32 s5, s5, 4
    s_lshr_b32 s6, s6, s5
    s_lshl_b32 s6, s6, 16
    v_mov_b32 v88, s6
    s_mov_b32 s5, 0x3fb8aa3b
    v_mul_f32 v89, s5, v88
    v_fma_f32 v90, v88, s5, -v89
    v_fmac_f32 v90, 0x32a57060, v88
    v_exp_f32 v89, v89
    v_mul_f32 v90, 0x3f317218, v90
    v_fmac_f32 v89, v89, v90
    v_cvt_pk_bf16_f32 v89, v89, v89
    v_lshlrev_b32 v10, 16, v89
    v_mul_f32 v8, s5, v10
    v_mul_f32 v9, 0x3e22f983, v10
    s_waitcnt vmcnt(0)
    v_lshlrev_b32 v24, 16, v24
    v_lshlrev_b32 v25, 16, v25
    v_lshlrev_b32 v26, 16, v26
    v_lshlrev_b32 v27, 16, v27
    v_lshlrev_b32 v28, 16, v28
    v_lshlrev_b32 v29, 16, v29
    v_mul_f32 v32, v24, v8
    v_mul_f32 v33, v25, v9
    v_mul_f32 v34, v28, v26
    v_mul_f32 v35, v28, v27
    v_fma_f32 v34, -v29, v27, v34
    v_fmac_f32 v35, v29, v26
    v_mul_f32 v34, v34, v10
    v_mul_f32 v35, v35, v10
    v_lshlrev_b32 v30, 4, v0
    ds_write_b128 v30, v[32:35] offset:12288
    s_lshl_b32 s5, s3, 10
    v_lshlrev_b32 v31, 4, v3
    v_add_u32 v31, s5, v31
    s_waitcnt lgkmcnt(0)
    ds_read_b128 v[36:39], v31 offset:12288
    ds_read_b128 v[40:43], v31 offset:12352
    ds_read_b128 v[44:47], v31 offset:12416
    ds_read_b128 v[48:51], v31 offset:12480
    s_waitcnt lgkmcnt(0)
    ds_read_b128 v[52:55], v31 offset:12544
    ds_read_b128 v[56:59], v31 offset:12608
    ds_read_b128 v[60:63], v31 offset:12672
    ds_read_b128 v[64:67], v31 offset:12736
    v_mul_f32 v68, v36, v7
    v_mul_f32 v69, v40, v7
    v_mul_f32 v70, v44, v7
    v_mul_f32 v71, v48, v7
    v_mul_f32 v72, v37, v7
    v_mul_f32 v73, v41, v7
    v_mul_f32 v74, v45, v7
    v_mul_f32 v75, v49, v7
    v_exp_f32 v68, v68
    v_exp_f32 v69, v69
    v_exp_f32 v70, v70
    v_exp_f32 v71, v71
    v_fract_f32 v72, v72
    v_fract_f32 v73, v73
    v_fract_f32 v74, v74
    v_fract_f32 v75, v75
    v_sin_f32 v76, v72
    v_sin_f32 v77, v73
    v_sin_f32 v78, v74
    v_sin_f32 v79, v75
    v_cos_f32 v72, v72
    v_cos_f32 v73, v73
    v_cos_f32 v74, v74
    v_cos_f32 v75, v75
    v_mul_f32 v84, v68, v76
    v_mul_f32 v85, v69, v77
    v_mul_f32 v86, v70, v78
    v_mul_f32 v87, v71, v79
    v_mul_f32 v80, v68, v72
    v_mul_f32 v81, v69, v73
    v_mul_f32 v82, v70, v74
    v_mul_f32 v83, v71, v75
    v_mul_f32 v68, v38, v80
    v_mul_f32 v69, v42, v81
    v_mul_f32 v70, v46, v82
    v_mul_f32 v71, v50, v83
    v_mul_f32 v72, v39, v80
    v_mul_f32 v73, v43, v81
    v_mul_f32 v74, v47, v82
    v_mul_f32 v75, v51, v83
    v_fma_f32 v68, -v39, v84, v68
    v_fma_f32 v69, -v43, v85, v69
    v_fma_f32 v70, -v47, v86, v70
    v_fma_f32 v71, -v51, v87, v71
    v_fma_f32 v72, -v38, v84, -v72
    v_fma_f32 v73, -v42, v85, -v73
    v_fma_f32 v74, -v46, v86, -v74
    v_fma_f32 v75, -v50, v87, -v75
    v_cvt_pk_bf16_f32 v96, v68, v72
    v_cvt_pk_bf16_f32 v97, v69, v73
    v_cvt_pk_bf16_f32 v98, v70, v74
    v_cvt_pk_bf16_f32 v99, v71, v75
    v_lshlrev_b32 v88, 16, v96
    v_lshlrev_b32 v89, 16, v97
    v_lshlrev_b32 v90, 16, v98
    v_lshlrev_b32 v91, 16, v99
    v_and_b32 v92, 0xffff0000, v96
    v_and_b32 v93, 0xffff0000, v97
    v_and_b32 v94, 0xffff0000, v98
    v_and_b32 v95, 0xffff0000, v99
    v_sub_f32 v68, v68, v88
    v_sub_f32 v69, v69, v89
    v_sub_f32 v70, v70, v90
    v_sub_f32 v71, v71, v91
    v_sub_f32 v72, v72, v92
    v_sub_f32 v73, v73, v93
    v_sub_f32 v74, v74, v94
    v_sub_f32 v75, v75, v95
    v_cvt_pk_bf16_f32 v100, v68, v72
    v_cvt_pk_bf16_f32 v101, v69, v73
    v_cvt_pk_bf16_f32 v102, v70, v74
    v_cvt_pk_bf16_f32 v103, v71, v75
    v_mul_f32 v68, v36, v4
    v_mul_f32 v69, v40, v4
    v_mul_f32 v70, v44, v4
    v_mul_f32 v71, v48, v4
    v_mul_f32 v72, v37, v4
    v_mul_f32 v73, v41, v4
    v_mul_f32 v74, v45, v4
    v_mul_f32 v75, v49, v4
    v_exp_f32 v68, v68
    v_exp_f32 v69, v69
    v_exp_f32 v70, v70
    v_exp_f32 v71, v71
    v_fract_f32 v72, v72
    v_fract_f32 v73, v73
    v_fract_f32 v74, v74
    v_fract_f32 v75, v75
    v_sin_f32 v76, v72
    v_sin_f32 v77, v73
    v_sin_f32 v78, v74
    v_sin_f32 v79, v75
    v_cos_f32 v72, v72
    v_cos_f32 v73, v73
    v_cos_f32 v74, v74
    v_cos_f32 v75, v75
    v_mul_f32 v84, v68, v76
    v_mul_f32 v85, v69, v77
    v_mul_f32 v86, v70, v78
    v_mul_f32 v87, v71, v79
    v_mul_f32 v80, v68, v72
    v_mul_f32 v81, v69, v73
    v_mul_f32 v82, v70, v74
    v_mul_f32 v83, v71, v75
    v_cvt_pk_bf16_f32 v104, v80, v84
    v_cvt_pk_bf16_f32 v105, v81, v85
    v_cvt_pk_bf16_f32 v106, v82, v86
    v_cvt_pk_bf16_f32 v107, v83, v87
    v_lshlrev_b32 v88, 16, v104
    v_lshlrev_b32 v89, 16, v105
    v_lshlrev_b32 v90, 16, v106
    v_lshlrev_b32 v91, 16, v107
    v_and_b32 v92, 0xffff0000, v104
    v_and_b32 v93, 0xffff0000, v105
    v_and_b32 v94, 0xffff0000, v106
    v_and_b32 v95, 0xffff0000, v107
    v_sub_f32 v80, v80, v88
    v_sub_f32 v81, v81, v89
    v_sub_f32 v82, v82, v90
    v_sub_f32 v83, v83, v91
    v_sub_f32 v84, v84, v92
    v_sub_f32 v85, v85, v93
    v_sub_f32 v86, v86, v94
    v_sub_f32 v87, v87, v95
    v_cvt_pk_bf16_f32 v24, v80, v84
    v_cvt_pk_bf16_f32 v25, v81, v85
    v_cvt_pk_bf16_f32 v26, v82, v86
    v_cvt_pk_bf16_f32 v27, v83, v87
    s_nop 1
    v_mfma_f32_16x16x32_bf16 v[12:15], v[104:107], v[96:99], v[12:15]
    v_mfma_f32_16x16x32_bf16 v[12:15], v[104:107], v[100:103], v[12:15]
    v_mfma_f32_16x16x32_bf16 v[12:15], v[24:27], v[96:99], v[12:15]
    v_mul_f32 v68, v36, v5
    v_mul_f32 v69, v40, v5
    v_mul_f32 v70, v44, v5
    v_mul_f32 v71, v48, v5
    v_mul_f32 v72, v37, v5
    v_mul_f32 v73, v41, v5
    v_mul_f32 v74, v45, v5
    v_mul_f32 v75, v49, v5
    v_exp_f32 v68, v68
    v_exp_f32 v69, v69
    v_exp_f32 v70, v70
    v_exp_f32 v71, v71
    v_fract_f32 v72, v72
    v_fract_f32 v73, v73
    v_fract_f32 v74, v74
    v_fract_f32 v75, v75
    v_sin_f32 v76, v72
    v_sin_f32 v77, v73
    v_sin_f32 v78, v74
    v_sin_f32 v79, v75
    v_cos_f32 v72, v72
    v_cos_f32 v73, v73
    v_cos_f32 v74, v74
    v_cos_f32 v75, v75
    v_mul_f32 v84, v68, v76
    v_mul_f32 v85, v69, v77
    v_mul_f32 v86, v70, v78
    v_mul_f32 v87, v71, v79
    v_mul_f32 v80, v68, v72
    v_mul_f32 v81, v69, v73
    v_mul_f32 v82, v70, v74
    v_mul_f32 v83, v71, v75
    v_cvt_pk_bf16_f32 v104, v80, v84
    v_cvt_pk_bf16_f32 v105, v81, v85
    v_cvt_pk_bf16_f32 v106, v82, v86
    v_cvt_pk_bf16_f32 v107, v83, v87
    v_lshlrev_b32 v88, 16, v104
    v_lshlrev_b32 v89, 16, v105
    v_lshlrev_b32 v90, 16, v106
    v_lshlrev_b32 v91, 16, v107
    v_and_b32 v92, 0xffff0000, v104
    v_and_b32 v93, 0xffff0000, v105
    v_and_b32 v94, 0xffff0000, v106
    v_and_b32 v95, 0xffff0000, v107
    v_sub_f32 v80, v80, v88
    v_sub_f32 v81, v81, v89
    v_sub_f32 v82, v82, v90
    v_sub_f32 v83, v83, v91
    v_sub_f32 v84, v84, v92
    v_sub_f32 v85, v85, v93
    v_sub_f32 v86, v86, v94
    v_sub_f32 v87, v87, v95
    v_cvt_pk_bf16_f32 v24, v80, v84
    v_cvt_pk_bf16_f32 v25, v81, v85
    v_cvt_pk_bf16_f32 v26, v82, v86
    v_cvt_pk_bf16_f32 v27, v83, v87
    s_nop 1
    v_mfma_f32_16x16x32_bf16 v[16:19], v[104:107], v[96:99], v[16:19]
    v_mfma_f32_16x16x32_bf16 v[16:19], v[104:107], v[100:103], v[16:19]
    v_mfma_f32_16x16x32_bf16 v[16:19], v[24:27], v[96:99], v[16:19]
    v_mul_f32 v68, v36, v6
    v_mul_f32 v69, v40, v6
    v_mul_f32 v70, v44, v6
    v_mul_f32 v71, v48, v6
    v_mul_f32 v72, v37, v6
    v_mul_f32 v73, v41, v6
    v_mul_f32 v74, v45, v6
    v_mul_f32 v75, v49, v6
    v_exp_f32 v68, v68
    v_exp_f32 v69, v69
    v_exp_f32 v70, v70
    v_exp_f32 v71, v71
    v_fract_f32 v72, v72
    v_fract_f32 v73, v73
    v_fract_f32 v74, v74
    v_fract_f32 v75, v75
    v_sin_f32 v76, v72
    v_sin_f32 v77, v73
    v_sin_f32 v78, v74
    v_sin_f32 v79, v75
    v_cos_f32 v72, v72
    v_cos_f32 v73, v73
    v_cos_f32 v74, v74
    v_cos_f32 v75, v75
    v_mul_f32 v84, v68, v76
    v_mul_f32 v85, v69, v77
    v_mul_f32 v86, v70, v78
    v_mul_f32 v87, v71, v79
    v_mul_f32 v80, v68, v72
    v_mul_f32 v81, v69, v73
    v_mul_f32 v82, v70, v74
    v_mul_f32 v83, v71, v75
    v_cvt_pk_bf16_f32 v104, v80, v84
    v_cvt_pk_bf16_f32 v105, v81, v85
    v_cvt_pk_bf16_f32 v106, v82, v86
    v_cvt_pk_bf16_f32 v107, v83, v87
    v_lshlrev_b32 v88, 16, v104
    v_lshlrev_b32 v89, 16, v105
    v_lshlrev_b32 v90, 16, v106
    v_lshlrev_b32 v91, 16, v107
    v_and_b32 v92, 0xffff0000, v104
    v_and_b32 v93, 0xffff0000, v105
    v_and_b32 v94, 0xffff0000, v106
    v_and_b32 v95, 0xffff0000, v107
    v_sub_f32 v80, v80, v88
    v_sub_f32 v81, v81, v89
    v_sub_f32 v82, v82, v90
    v_sub_f32 v83, v83, v91
    v_sub_f32 v84, v84, v92
    v_sub_f32 v85, v85, v93
    v_sub_f32 v86, v86, v94
    v_sub_f32 v87, v87, v95
    v_cvt_pk_bf16_f32 v24, v80, v84
    v_cvt_pk_bf16_f32 v25, v81, v85
    v_cvt_pk_bf16_f32 v26, v82, v86
    v_cvt_pk_bf16_f32 v27, v83, v87
    s_nop 1
    v_mfma_f32_16x16x32_bf16 v[20:23], v[104:107], v[96:99], v[20:23]
    v_mfma_f32_16x16x32_bf16 v[20:23], v[104:107], v[100:103], v[20:23]
    v_mfma_f32_16x16x32_bf16 v[20:23], v[24:27], v[96:99], v[20:23]
    s_waitcnt lgkmcnt(0)
    ds_read_b128 v[36:39], v31 offset:12800
    ds_read_b128 v[40:43], v31 offset:12864
    ds_read_b128 v[44:47], v31 offset:12928
    ds_read_b128 v[48:51], v31 offset:12992
    v_mul_f32 v68, v52, v7
    v_mul_f32 v69, v56, v7
    v_mul_f32 v70, v60, v7
    v_mul_f32 v71, v64, v7
    v_mul_f32 v72, v53, v7
    v_mul_f32 v73, v57, v7
    v_mul_f32 v74, v61, v7
    v_mul_f32 v75, v65, v7
    v_exp_f32 v68, v68
    v_exp_f32 v69, v69
    v_exp_f32 v70, v70
    v_exp_f32 v71, v71
    v_fract_f32 v72, v72
    v_fract_f32 v73, v73
    v_fract_f32 v74, v74
    v_fract_f32 v75, v75
    v_sin_f32 v76, v72
    v_sin_f32 v77, v73
    v_sin_f32 v78, v74
    v_sin_f32 v79, v75
    v_cos_f32 v72, v72
    v_cos_f32 v73, v73
    v_cos_f32 v74, v74
    v_cos_f32 v75, v75
    v_mul_f32 v84, v68, v76
    v_mul_f32 v85, v69, v77
    v_mul_f32 v86, v70, v78
    v_mul_f32 v87, v71, v79
    v_mul_f32 v80, v68, v72
    v_mul_f32 v81, v69, v73
    v_mul_f32 v82, v70, v74
    v_mul_f32 v83, v71, v75
    v_mul_f32 v68, v54, v80
    v_mul_f32 v69, v58, v81
    v_mul_f32 v70, v62, v82
    v_mul_f32 v71, v66, v83
    v_mul_f32 v72, v55, v80
    v_mul_f32 v73, v59, v81
    v_mul_f32 v74, v63, v82
    v_mul_f32 v75, v67, v83
    v_fma_f32 v68, -v55, v84, v68
    v_fma_f32 v69, -v59, v85, v69
    v_fma_f32 v70, -v63, v86, v70
    v_fma_f32 v71, -v67, v87, v71
    v_fma_f32 v72, -v54, v84, -v72
    v_fma_f32 v73, -v58, v85, -v73
    v_fma_f32 v74, -v62, v86, -v74
    v_fma_f32 v75, -v66, v87, -v75
    v_cvt_pk_bf16_f32 v96, v68, v72
    v_cvt_pk_bf16_f32 v97, v69, v73
    v_cvt_pk_bf16_f32 v98, v70, v74
    v_cvt_pk_bf16_f32 v99, v71, v75
    v_lshlrev_b32 v88, 16, v96
    v_lshlrev_b32 v89, 16, v97
    v_lshlrev_b32 v90, 16, v98
    v_lshlrev_b32 v91, 16, v99
    v_and_b32 v92, 0xffff0000, v96
    v_and_b32 v93, 0xffff0000, v97
    v_and_b32 v94, 0xffff0000, v98
    v_and_b32 v95, 0xffff0000, v99
    v_sub_f32 v68, v68, v88
    v_sub_f32 v69, v69, v89
    v_sub_f32 v70, v70, v90
    v_sub_f32 v71, v71, v91
    v_sub_f32 v72, v72, v92
    v_sub_f32 v73, v73, v93
    v_sub_f32 v74, v74, v94
    v_sub_f32 v75, v75, v95
    v_cvt_pk_bf16_f32 v100, v68, v72
    v_cvt_pk_bf16_f32 v101, v69, v73
    v_cvt_pk_bf16_f32 v102, v70, v74
    v_cvt_pk_bf16_f32 v103, v71, v75
    v_mul_f32 v68, v52, v4
    v_mul_f32 v69, v56, v4
    v_mul_f32 v70, v60, v4
    v_mul_f32 v71, v64, v4
    v_mul_f32 v72, v53, v4
    v_mul_f32 v73, v57, v4
    v_mul_f32 v74, v61, v4
    v_mul_f32 v75, v65, v4
    v_exp_f32 v68, v68
    v_exp_f32 v69, v69
    v_exp_f32 v70, v70
    v_exp_f32 v71, v71
    v_fract_f32 v72, v72
    v_fract_f32 v73, v73
    v_fract_f32 v74, v74
    v_fract_f32 v75, v75
    v_sin_f32 v76, v72
    v_sin_f32 v77, v73
    v_sin_f32 v78, v74
    v_sin_f32 v79, v75
    v_cos_f32 v72, v72
    v_cos_f32 v73, v73
    v_cos_f32 v74, v74
    v_cos_f32 v75, v75
    v_mul_f32 v84, v68, v76
    v_mul_f32 v85, v69, v77
    v_mul_f32 v86, v70, v78
    v_mul_f32 v87, v71, v79
    v_mul_f32 v80, v68, v72
    v_mul_f32 v81, v69, v73
    v_mul_f32 v82, v70, v74
    v_mul_f32 v83, v71, v75
    v_cvt_pk_bf16_f32 v104, v80, v84
    v_cvt_pk_bf16_f32 v105, v81, v85
    v_cvt_pk_bf16_f32 v106, v82, v86
    v_cvt_pk_bf16_f32 v107, v83, v87
    v_lshlrev_b32 v88, 16, v104
    v_lshlrev_b32 v89, 16, v105
    v_lshlrev_b32 v90, 16, v106
    v_lshlrev_b32 v91, 16, v107
    v_and_b32 v92, 0xffff0000, v104
    v_and_b32 v93, 0xffff0000, v105
    v_and_b32 v94, 0xffff0000, v106
    v_and_b32 v95, 0xffff0000, v107
    v_sub_f32 v80, v80, v88
    v_sub_f32 v81, v81, v89
    v_sub_f32 v82, v82, v90
    v_sub_f32 v83, v83, v91
    v_sub_f32 v84, v84, v92
    v_sub_f32 v85, v85, v93
    v_sub_f32 v86, v86, v94
    v_sub_f32 v87, v87, v95
    v_cvt_pk_bf16_f32 v24, v80, v84
    v_cvt_pk_bf16_f32 v25, v81, v85
    v_cvt_pk_bf16_f32 v26, v82, v86
    v_cvt_pk_bf16_f32 v27, v83, v87
    s_nop 1
    v_mfma_f32_16x16x32_bf16 v[12:15], v[104:107], v[96:99], v[12:15]
    v_mfma_f32_16x16x32_bf16 v[12:15], v[104:107], v[100:103], v[12:15]
    v_mfma_f32_16x16x32_bf16 v[12:15], v[24:27], v[96:99], v[12:15]
    v_mul_f32 v68, v52, v5
    v_mul_f32 v69, v56, v5
    v_mul_f32 v70, v60, v5
    v_mul_f32 v71, v64, v5
    v_mul_f32 v72, v53, v5
    v_mul_f32 v73, v57, v5
    v_mul_f32 v74, v61, v5
    v_mul_f32 v75, v65, v5
    v_exp_f32 v68, v68
    v_exp_f32 v69, v69
    v_exp_f32 v70, v70
    v_exp_f32 v71, v71
    v_fract_f32 v72, v72
    v_fract_f32 v73, v73
    v_fract_f32 v74, v74
    v_fract_f32 v75, v75
    v_sin_f32 v76, v72
    v_sin_f32 v77, v73
    v_sin_f32 v78, v74
    v_sin_f32 v79, v75
    v_cos_f32 v72, v72
    v_cos_f32 v73, v73
    v_cos_f32 v74, v74
    v_cos_f32 v75, v75
    v_mul_f32 v84, v68, v76
    v_mul_f32 v85, v69, v77
    v_mul_f32 v86, v70, v78
    v_mul_f32 v87, v71, v79
    v_mul_f32 v80, v68, v72
    v_mul_f32 v81, v69, v73
    v_mul_f32 v82, v70, v74
    v_mul_f32 v83, v71, v75
    v_cvt_pk_bf16_f32 v104, v80, v84
    v_cvt_pk_bf16_f32 v105, v81, v85
    v_cvt_pk_bf16_f32 v106, v82, v86
    v_cvt_pk_bf16_f32 v107, v83, v87
    v_lshlrev_b32 v88, 16, v104
    v_lshlrev_b32 v89, 16, v105
    v_lshlrev_b32 v90, 16, v106
    v_lshlrev_b32 v91, 16, v107
    v_and_b32 v92, 0xffff0000, v104
    v_and_b32 v93, 0xffff0000, v105
    v_and_b32 v94, 0xffff0000, v106
    v_and_b32 v95, 0xffff0000, v107
    v_sub_f32 v80, v80, v88
    v_sub_f32 v81, v81, v89
    v_sub_f32 v82, v82, v90
    v_sub_f32 v83, v83, v91
    v_sub_f32 v84, v84, v92
    v_sub_f32 v85, v85, v93
    v_sub_f32 v86, v86, v94
    v_sub_f32 v87, v87, v95
    v_cvt_pk_bf16_f32 v24, v80, v84
    v_cvt_pk_bf16_f32 v25, v81, v85
    v_cvt_pk_bf16_f32 v26, v82, v86
    v_cvt_pk_bf16_f32 v27, v83, v87
    s_nop 1
    v_mfma_f32_16x16x32_bf16 v[16:19], v[104:107], v[96:99], v[16:19]
    v_mfma_f32_16x16x32_bf16 v[16:19], v[104:107], v[100:103], v[16:19]
    v_mfma_f32_16x16x32_bf16 v[16:19], v[24:27], v[96:99], v[16:19]
    v_mul_f32 v68, v52, v6
    v_mul_f32 v69, v56, v6
    v_mul_f32 v70, v60, v6
    v_mul_f32 v71, v64, v6
    v_mul_f32 v72, v53, v6
    v_mul_f32 v73, v57, v6
    v_mul_f32 v74, v61, v6
    v_mul_f32 v75, v65, v6
    v_exp_f32 v68, v68
    v_exp_f32 v69, v69
    v_exp_f32 v70, v70
    v_exp_f32 v71, v71
    v_fract_f32 v72, v72
    v_fract_f32 v73, v73
    v_fract_f32 v74, v74
    v_fract_f32 v75, v75
    v_sin_f32 v76, v72
    v_sin_f32 v77, v73
    v_sin_f32 v78, v74
    v_sin_f32 v79, v75
    v_cos_f32 v72, v72
    v_cos_f32 v73, v73
    v_cos_f32 v74, v74
    v_cos_f32 v75, v75
    v_mul_f32 v84, v68, v76
    v_mul_f32 v85, v69, v77
    v_mul_f32 v86, v70, v78
    v_mul_f32 v87, v71, v79
    v_mul_f32 v80, v68, v72
    v_mul_f32 v81, v69, v73
    v_mul_f32 v82, v70, v74
    v_mul_f32 v83, v71, v75
    v_cvt_pk_bf16_f32 v104, v80, v84
    v_cvt_pk_bf16_f32 v105, v81, v85
    v_cvt_pk_bf16_f32 v106, v82, v86
    v_cvt_pk_bf16_f32 v107, v83, v87
    v_lshlrev_b32 v88, 16, v104
    v_lshlrev_b32 v89, 16, v105
    v_lshlrev_b32 v90, 16, v106
    v_lshlrev_b32 v91, 16, v107
    v_and_b32 v92, 0xffff0000, v104
    v_and_b32 v93, 0xffff0000, v105
    v_and_b32 v94, 0xffff0000, v106
    v_and_b32 v95, 0xffff0000, v107
    v_sub_f32 v80, v80, v88
    v_sub_f32 v81, v81, v89
    v_sub_f32 v82, v82, v90
    v_sub_f32 v83, v83, v91
    v_sub_f32 v84, v84, v92
    v_sub_f32 v85, v85, v93
    v_sub_f32 v86, v86, v94
    v_sub_f32 v87, v87, v95
    v_cvt_pk_bf16_f32 v24, v80, v84
    v_cvt_pk_bf16_f32 v25, v81, v85
    v_cvt_pk_bf16_f32 v26, v82, v86
    v_cvt_pk_bf16_f32 v27, v83, v87
    s_nop 1
    v_mfma_f32_16x16x32_bf16 v[20:23], v[104:107], v[96:99], v[20:23]
    v_mfma_f32_16x16x32_bf16 v[20:23], v[104:107], v[100:103], v[20:23]
    v_mfma_f32_16x16x32_bf16 v[20:23], v[24:27], v[96:99], v[20:23]
    s_waitcnt lgkmcnt(0)
    ds_read_b128 v[52:55], v31 offset:13056
    ds_read_b128 v[56:59], v31 offset:13120
    ds_read_b128 v[60:63], v31 offset:13184
    ds_read_b128 v[64:67], v31 offset:13248
    v_mul_f32 v68, v36, v7
    v_mul_f32 v69, v40, v7
    v_mul_f32 v70, v44, v7
    v_mul_f32 v71, v48, v7
    v_mul_f32 v72, v37, v7
    v_mul_f32 v73, v41, v7
    v_mul_f32 v74, v45, v7
    v_mul_f32 v75, v49, v7
    v_exp_f32 v68, v68
    v_exp_f32 v69, v69
    v_exp_f32 v70, v70
    v_exp_f32 v71, v71
    v_fract_f32 v72, v72
    v_fract_f32 v73, v73
    v_fract_f32 v74, v74
    v_fract_f32 v75, v75
    v_sin_f32 v76, v72
    v_sin_f32 v77, v73
    v_sin_f32 v78, v74
    v_sin_f32 v79, v75
    v_cos_f32 v72, v72
    v_cos_f32 v73, v73
    v_cos_f32 v74, v74
    v_cos_f32 v75, v75
    v_mul_f32 v84, v68, v76
    v_mul_f32 v85, v69, v77
    v_mul_f32 v86, v70, v78
    v_mul_f32 v87, v71, v79
    v_mul_f32 v80, v68, v72
    v_mul_f32 v81, v69, v73
    v_mul_f32 v82, v70, v74
    v_mul_f32 v83, v71, v75
    v_mul_f32 v68, v38, v80
    v_mul_f32 v69, v42, v81
    v_mul_f32 v70, v46, v82
    v_mul_f32 v71, v50, v83
    v_mul_f32 v72, v39, v80
    v_mul_f32 v73, v43, v81
    v_mul_f32 v74, v47, v82
    v_mul_f32 v75, v51, v83
    v_fma_f32 v68, -v39, v84, v68
    v_fma_f32 v69, -v43, v85, v69
    v_fma_f32 v70, -v47, v86, v70
    v_fma_f32 v71, -v51, v87, v71
    v_fma_f32 v72, -v38, v84, -v72
    v_fma_f32 v73, -v42, v85, -v73
    v_fma_f32 v74, -v46, v86, -v74
    v_fma_f32 v75, -v50, v87, -v75
    v_cvt_pk_bf16_f32 v96, v68, v72
    v_cvt_pk_bf16_f32 v97, v69, v73
    v_cvt_pk_bf16_f32 v98, v70, v74
    v_cvt_pk_bf16_f32 v99, v71, v75
    v_lshlrev_b32 v88, 16, v96
    v_lshlrev_b32 v89, 16, v97
    v_lshlrev_b32 v90, 16, v98
    v_lshlrev_b32 v91, 16, v99
    v_and_b32 v92, 0xffff0000, v96
    v_and_b32 v93, 0xffff0000, v97
    v_and_b32 v94, 0xffff0000, v98
    v_and_b32 v95, 0xffff0000, v99
    v_sub_f32 v68, v68, v88
    v_sub_f32 v69, v69, v89
    v_sub_f32 v70, v70, v90
    v_sub_f32 v71, v71, v91
    v_sub_f32 v72, v72, v92
    v_sub_f32 v73, v73, v93
    v_sub_f32 v74, v74, v94
    v_sub_f32 v75, v75, v95
    v_cvt_pk_bf16_f32 v100, v68, v72
    v_cvt_pk_bf16_f32 v101, v69, v73
    v_cvt_pk_bf16_f32 v102, v70, v74
    v_cvt_pk_bf16_f32 v103, v71, v75
    v_mul_f32 v68, v36, v4
    v_mul_f32 v69, v40, v4
    v_mul_f32 v70, v44, v4
    v_mul_f32 v71, v48, v4
    v_mul_f32 v72, v37, v4
    v_mul_f32 v73, v41, v4
    v_mul_f32 v74, v45, v4
    v_mul_f32 v75, v49, v4
    v_exp_f32 v68, v68
    v_exp_f32 v69, v69
    v_exp_f32 v70, v70
    v_exp_f32 v71, v71
    v_fract_f32 v72, v72
    v_fract_f32 v73, v73
    v_fract_f32 v74, v74
    v_fract_f32 v75, v75
    v_sin_f32 v76, v72
    v_sin_f32 v77, v73
    v_sin_f32 v78, v74
    v_sin_f32 v79, v75
    v_cos_f32 v72, v72
    v_cos_f32 v73, v73
    v_cos_f32 v74, v74
    v_cos_f32 v75, v75
    v_mul_f32 v84, v68, v76
    v_mul_f32 v85, v69, v77
    v_mul_f32 v86, v70, v78
    v_mul_f32 v87, v71, v79
    v_mul_f32 v80, v68, v72
    v_mul_f32 v81, v69, v73
    v_mul_f32 v82, v70, v74
    v_mul_f32 v83, v71, v75
    v_cvt_pk_bf16_f32 v104, v80, v84
    v_cvt_pk_bf16_f32 v105, v81, v85
    v_cvt_pk_bf16_f32 v106, v82, v86
    v_cvt_pk_bf16_f32 v107, v83, v87
    v_lshlrev_b32 v88, 16, v104
    v_lshlrev_b32 v89, 16, v105
    v_lshlrev_b32 v90, 16, v106
    v_lshlrev_b32 v91, 16, v107
    v_and_b32 v92, 0xffff0000, v104
    v_and_b32 v93, 0xffff0000, v105
    v_and_b32 v94, 0xffff0000, v106
    v_and_b32 v95, 0xffff0000, v107
    v_sub_f32 v80, v80, v88
    v_sub_f32 v81, v81, v89
    v_sub_f32 v82, v82, v90
    v_sub_f32 v83, v83, v91
    v_sub_f32 v84, v84, v92
    v_sub_f32 v85, v85, v93
    v_sub_f32 v86, v86, v94
    v_sub_f32 v87, v87, v95
    v_cvt_pk_bf16_f32 v24, v80, v84
    v_cvt_pk_bf16_f32 v25, v81, v85
    v_cvt_pk_bf16_f32 v26, v82, v86
    v_cvt_pk_bf16_f32 v27, v83, v87
    s_nop 1
    v_mfma_f32_16x16x32_bf16 v[12:15], v[104:107], v[96:99], v[12:15]
    v_mfma_f32_16x16x32_bf16 v[12:15], v[104:107], v[100:103], v[12:15]
    v_mfma_f32_16x16x32_bf16 v[12:15], v[24:27], v[96:99], v[12:15]
    v_mul_f32 v68, v36, v5
    v_mul_f32 v69, v40, v5
    v_mul_f32 v70, v44, v5
    v_mul_f32 v71, v48, v5
    v_mul_f32 v72, v37, v5
    v_mul_f32 v73, v41, v5
    v_mul_f32 v74, v45, v5
    v_mul_f32 v75, v49, v5
    v_exp_f32 v68, v68
    v_exp_f32 v69, v69
    v_exp_f32 v70, v70
    v_exp_f32 v71, v71
    v_fract_f32 v72, v72
    v_fract_f32 v73, v73
    v_fract_f32 v74, v74
    v_fract_f32 v75, v75
    v_sin_f32 v76, v72
    v_sin_f32 v77, v73
    v_sin_f32 v78, v74
    v_sin_f32 v79, v75
    v_cos_f32 v72, v72
    v_cos_f32 v73, v73
    v_cos_f32 v74, v74
    v_cos_f32 v75, v75
    v_mul_f32 v84, v68, v76
    v_mul_f32 v85, v69, v77
    v_mul_f32 v86, v70, v78
    v_mul_f32 v87, v71, v79
    v_mul_f32 v80, v68, v72
    v_mul_f32 v81, v69, v73
    v_mul_f32 v82, v70, v74
    v_mul_f32 v83, v71, v75
    v_cvt_pk_bf16_f32 v104, v80, v84
    v_cvt_pk_bf16_f32 v105, v81, v85
    v_cvt_pk_bf16_f32 v106, v82, v86
    v_cvt_pk_bf16_f32 v107, v83, v87
    v_lshlrev_b32 v88, 16, v104
    v_lshlrev_b32 v89, 16, v105
    v_lshlrev_b32 v90, 16, v106
    v_lshlrev_b32 v91, 16, v107
    v_and_b32 v92, 0xffff0000, v104
    v_and_b32 v93, 0xffff0000, v105
    v_and_b32 v94, 0xffff0000, v106
    v_and_b32 v95, 0xffff0000, v107
    v_sub_f32 v80, v80, v88
    v_sub_f32 v81, v81, v89
    v_sub_f32 v82, v82, v90
    v_sub_f32 v83, v83, v91
    v_sub_f32 v84, v84, v92
    v_sub_f32 v85, v85, v93
    v_sub_f32 v86, v86, v94
    v_sub_f32 v87, v87, v95
    v_cvt_pk_bf16_f32 v24, v80, v84
    v_cvt_pk_bf16_f32 v25, v81, v85
    v_cvt_pk_bf16_f32 v26, v82, v86
    v_cvt_pk_bf16_f32 v27, v83, v87
    s_nop 1
    v_mfma_f32_16x16x32_bf16 v[16:19], v[104:107], v[96:99], v[16:19]
    v_mfma_f32_16x16x32_bf16 v[16:19], v[104:107], v[100:103], v[16:19]
    v_mfma_f32_16x16x32_bf16 v[16:19], v[24:27], v[96:99], v[16:19]
    v_mul_f32 v68, v36, v6
    v_mul_f32 v69, v40, v6
    v_mul_f32 v70, v44, v6
    v_mul_f32 v71, v48, v6
    v_mul_f32 v72, v37, v6
    v_mul_f32 v73, v41, v6
    v_mul_f32 v74, v45, v6
    v_mul_f32 v75, v49, v6
    v_exp_f32 v68, v68
    v_exp_f32 v69, v69
    v_exp_f32 v70, v70
    v_exp_f32 v71, v71
    v_fract_f32 v72, v72
    v_fract_f32 v73, v73
    v_fract_f32 v74, v74
    v_fract_f32 v75, v75
    v_sin_f32 v76, v72
    v_sin_f32 v77, v73
    v_sin_f32 v78, v74
    v_sin_f32 v79, v75
    v_cos_f32 v72, v72
    v_cos_f32 v73, v73
    v_cos_f32 v74, v74
    v_cos_f32 v75, v75
    v_mul_f32 v84, v68, v76
    v_mul_f32 v85, v69, v77
    v_mul_f32 v86, v70, v78
    v_mul_f32 v87, v71, v79
    v_mul_f32 v80, v68, v72
    v_mul_f32 v81, v69, v73
    v_mul_f32 v82, v70, v74
    v_mul_f32 v83, v71, v75
    v_cvt_pk_bf16_f32 v104, v80, v84
    v_cvt_pk_bf16_f32 v105, v81, v85
    v_cvt_pk_bf16_f32 v106, v82, v86
    v_cvt_pk_bf16_f32 v107, v83, v87
    v_lshlrev_b32 v88, 16, v104
    v_lshlrev_b32 v89, 16, v105
    v_lshlrev_b32 v90, 16, v106
    v_lshlrev_b32 v91, 16, v107
    v_and_b32 v92, 0xffff0000, v104
    v_and_b32 v93, 0xffff0000, v105
    v_and_b32 v94, 0xffff0000, v106
    v_and_b32 v95, 0xffff0000, v107
    v_sub_f32 v80, v80, v88
    v_sub_f32 v81, v81, v89
    v_sub_f32 v82, v82, v90
    v_sub_f32 v83, v83, v91
    v_sub_f32 v84, v84, v92
    v_sub_f32 v85, v85, v93
    v_sub_f32 v86, v86, v94
    v_sub_f32 v87, v87, v95
    v_cvt_pk_bf16_f32 v24, v80, v84
    v_cvt_pk_bf16_f32 v25, v81, v85
    v_cvt_pk_bf16_f32 v26, v82, v86
    v_cvt_pk_bf16_f32 v27, v83, v87
    s_nop 1
    v_mfma_f32_16x16x32_bf16 v[20:23], v[104:107], v[96:99], v[20:23]
    v_mfma_f32_16x16x32_bf16 v[20:23], v[104:107], v[100:103], v[20:23]
    v_mfma_f32_16x16x32_bf16 v[20:23], v[24:27], v[96:99], v[20:23]
    s_waitcnt lgkmcnt(0)
    v_mul_f32 v68, v52, v7
    v_mul_f32 v69, v56, v7
    v_mul_f32 v70, v60, v7
    v_mul_f32 v71, v64, v7
    v_mul_f32 v72, v53, v7
    v_mul_f32 v73, v57, v7
    v_mul_f32 v74, v61, v7
    v_mul_f32 v75, v65, v7
    v_exp_f32 v68, v68
    v_exp_f32 v69, v69
    v_exp_f32 v70, v70
    v_exp_f32 v71, v71
    v_fract_f32 v72, v72
    v_fract_f32 v73, v73
    v_fract_f32 v74, v74
    v_fract_f32 v75, v75
    v_sin_f32 v76, v72
    v_sin_f32 v77, v73
    v_sin_f32 v78, v74
    v_sin_f32 v79, v75
    v_cos_f32 v72, v72
    v_cos_f32 v73, v73
    v_cos_f32 v74, v74
    v_cos_f32 v75, v75
    v_mul_f32 v84, v68, v76
    v_mul_f32 v85, v69, v77
    v_mul_f32 v86, v70, v78
    v_mul_f32 v87, v71, v79
    v_mul_f32 v80, v68, v72
    v_mul_f32 v81, v69, v73
    v_mul_f32 v82, v70, v74
    v_mul_f32 v83, v71, v75
    v_mul_f32 v68, v54, v80
    v_mul_f32 v69, v58, v81
    v_mul_f32 v70, v62, v82
    v_mul_f32 v71, v66, v83
    v_mul_f32 v72, v55, v80
    v_mul_f32 v73, v59, v81
    v_mul_f32 v74, v63, v82
    v_mul_f32 v75, v67, v83
    v_fma_f32 v68, -v55, v84, v68
    v_fma_f32 v69, -v59, v85, v69
    v_fma_f32 v70, -v63, v86, v70
    v_fma_f32 v71, -v67, v87, v71
    v_fma_f32 v72, -v54, v84, -v72
    v_fma_f32 v73, -v58, v85, -v73
    v_fma_f32 v74, -v62, v86, -v74
    v_fma_f32 v75, -v66, v87, -v75
    v_cvt_pk_bf16_f32 v96, v68, v72
    v_cvt_pk_bf16_f32 v97, v69, v73
    v_cvt_pk_bf16_f32 v98, v70, v74
    v_cvt_pk_bf16_f32 v99, v71, v75
    v_lshlrev_b32 v88, 16, v96
    v_lshlrev_b32 v89, 16, v97
    v_lshlrev_b32 v90, 16, v98
    v_lshlrev_b32 v91, 16, v99
    v_and_b32 v92, 0xffff0000, v96
    v_and_b32 v93, 0xffff0000, v97
    v_and_b32 v94, 0xffff0000, v98
    v_and_b32 v95, 0xffff0000, v99
    v_sub_f32 v68, v68, v88
    v_sub_f32 v69, v69, v89
    v_sub_f32 v70, v70, v90
    v_sub_f32 v71, v71, v91
    v_sub_f32 v72, v72, v92
    v_sub_f32 v73, v73, v93
    v_sub_f32 v74, v74, v94
    v_sub_f32 v75, v75, v95
    v_cvt_pk_bf16_f32 v100, v68, v72
    v_cvt_pk_bf16_f32 v101, v69, v73
    v_cvt_pk_bf16_f32 v102, v70, v74
    v_cvt_pk_bf16_f32 v103, v71, v75
    v_mul_f32 v68, v52, v4
    v_mul_f32 v69, v56, v4
    v_mul_f32 v70, v60, v4
    v_mul_f32 v71, v64, v4
    v_mul_f32 v72, v53, v4
    v_mul_f32 v73, v57, v4
    v_mul_f32 v74, v61, v4
    v_mul_f32 v75, v65, v4
    v_exp_f32 v68, v68
    v_exp_f32 v69, v69
    v_exp_f32 v70, v70
    v_exp_f32 v71, v71
    v_fract_f32 v72, v72
    v_fract_f32 v73, v73
    v_fract_f32 v74, v74
    v_fract_f32 v75, v75
    v_sin_f32 v76, v72
    v_sin_f32 v77, v73
    v_sin_f32 v78, v74
    v_sin_f32 v79, v75
    v_cos_f32 v72, v72
    v_cos_f32 v73, v73
    v_cos_f32 v74, v74
    v_cos_f32 v75, v75
    v_mul_f32 v84, v68, v76
    v_mul_f32 v85, v69, v77
    v_mul_f32 v86, v70, v78
    v_mul_f32 v87, v71, v79
    v_mul_f32 v80, v68, v72
    v_mul_f32 v81, v69, v73
    v_mul_f32 v82, v70, v74
    v_mul_f32 v83, v71, v75
    v_cvt_pk_bf16_f32 v104, v80, v84
    v_cvt_pk_bf16_f32 v105, v81, v85
    v_cvt_pk_bf16_f32 v106, v82, v86
    v_cvt_pk_bf16_f32 v107, v83, v87
    v_lshlrev_b32 v88, 16, v104
    v_lshlrev_b32 v89, 16, v105
    v_lshlrev_b32 v90, 16, v106
    v_lshlrev_b32 v91, 16, v107
    v_and_b32 v92, 0xffff0000, v104
    v_and_b32 v93, 0xffff0000, v105
    v_and_b32 v94, 0xffff0000, v106
    v_and_b32 v95, 0xffff0000, v107
    v_sub_f32 v80, v80, v88
    v_sub_f32 v81, v81, v89
    v_sub_f32 v82, v82, v90
    v_sub_f32 v83, v83, v91
    v_sub_f32 v84, v84, v92
    v_sub_f32 v85, v85, v93
    v_sub_f32 v86, v86, v94
    v_sub_f32 v87, v87, v95
    v_cvt_pk_bf16_f32 v24, v80, v84
    v_cvt_pk_bf16_f32 v25, v81, v85
    v_cvt_pk_bf16_f32 v26, v82, v86
    v_cvt_pk_bf16_f32 v27, v83, v87
    s_nop 1
    v_mfma_f32_16x16x32_bf16 v[12:15], v[104:107], v[96:99], v[12:15]
    v_mfma_f32_16x16x32_bf16 v[12:15], v[104:107], v[100:103], v[12:15]
    v_mfma_f32_16x16x32_bf16 v[12:15], v[24:27], v[96:99], v[12:15]
    v_mul_f32 v68, v52, v5
    v_mul_f32 v69, v56, v5
    v_mul_f32 v70, v60, v5
    v_mul_f32 v71, v64, v5
    v_mul_f32 v72, v53, v5
    v_mul_f32 v73, v57, v5
    v_mul_f32 v74, v61, v5
    v_mul_f32 v75, v65, v5
    v_exp_f32 v68, v68
    v_exp_f32 v69, v69
    v_exp_f32 v70, v70
    v_exp_f32 v71, v71
    v_fract_f32 v72, v72
    v_fract_f32 v73, v73
    v_fract_f32 v74, v74
    v_fract_f32 v75, v75
    v_sin_f32 v76, v72
    v_sin_f32 v77, v73
    v_sin_f32 v78, v74
    v_sin_f32 v79, v75
    v_cos_f32 v72, v72
    v_cos_f32 v73, v73
    v_cos_f32 v74, v74
    v_cos_f32 v75, v75
    v_mul_f32 v84, v68, v76
    v_mul_f32 v85, v69, v77
    v_mul_f32 v86, v70, v78
    v_mul_f32 v87, v71, v79
    v_mul_f32 v80, v68, v72
    v_mul_f32 v81, v69, v73
    v_mul_f32 v82, v70, v74
    v_mul_f32 v83, v71, v75
    v_cvt_pk_bf16_f32 v104, v80, v84
    v_cvt_pk_bf16_f32 v105, v81, v85
    v_cvt_pk_bf16_f32 v106, v82, v86
    v_cvt_pk_bf16_f32 v107, v83, v87
    v_lshlrev_b32 v88, 16, v104
    v_lshlrev_b32 v89, 16, v105
    v_lshlrev_b32 v90, 16, v106
    v_lshlrev_b32 v91, 16, v107
    v_and_b32 v92, 0xffff0000, v104
    v_and_b32 v93, 0xffff0000, v105
    v_and_b32 v94, 0xffff0000, v106
    v_and_b32 v95, 0xffff0000, v107
    v_sub_f32 v80, v80, v88
    v_sub_f32 v81, v81, v89
    v_sub_f32 v82, v82, v90
    v_sub_f32 v83, v83, v91
    v_sub_f32 v84, v84, v92
    v_sub_f32 v85, v85, v93
    v_sub_f32 v86, v86, v94
    v_sub_f32 v87, v87, v95
    v_cvt_pk_bf16_f32 v24, v80, v84
    v_cvt_pk_bf16_f32 v25, v81, v85
    v_cvt_pk_bf16_f32 v26, v82, v86
    v_cvt_pk_bf16_f32 v27, v83, v87
    s_nop 1
    v_mfma_f32_16x16x32_bf16 v[16:19], v[104:107], v[96:99], v[16:19]
    v_mfma_f32_16x16x32_bf16 v[16:19], v[104:107], v[100:103], v[16:19]
    v_mfma_f32_16x16x32_bf16 v[16:19], v[24:27], v[96:99], v[16:19]
    v_mul_f32 v68, v52, v6
    v_mul_f32 v69, v56, v6
    v_mul_f32 v70, v60, v6
    v_mul_f32 v71, v64, v6
    v_mul_f32 v72, v53, v6
    v_mul_f32 v73, v57, v6
    v_mul_f32 v74, v61, v6
    v_mul_f32 v75, v65, v6
    v_exp_f32 v68, v68
    v_exp_f32 v69, v69
    v_exp_f32 v70, v70
    v_exp_f32 v71, v71
    v_fract_f32 v72, v72
    v_fract_f32 v73, v73
    v_fract_f32 v74, v74
    v_fract_f32 v75, v75
    v_sin_f32 v76, v72
    v_sin_f32 v77, v73
    v_sin_f32 v78, v74
    v_sin_f32 v79, v75
    v_cos_f32 v72, v72
    v_cos_f32 v73, v73
    v_cos_f32 v74, v74
    v_cos_f32 v75, v75
    v_mul_f32 v84, v68, v76
    v_mul_f32 v85, v69, v77
    v_mul_f32 v86, v70, v78
    v_mul_f32 v87, v71, v79
    v_mul_f32 v80, v68, v72
    v_mul_f32 v81, v69, v73
    v_mul_f32 v82, v70, v74
    v_mul_f32 v83, v71, v75
    v_cvt_pk_bf16_f32 v104, v80, v84
    v_cvt_pk_bf16_f32 v105, v81, v85
    v_cvt_pk_bf16_f32 v106, v82, v86
    v_cvt_pk_bf16_f32 v107, v83, v87
    v_lshlrev_b32 v88, 16, v104
    v_lshlrev_b32 v89, 16, v105
    v_lshlrev_b32 v90, 16, v106
    v_lshlrev_b32 v91, 16, v107
    v_and_b32 v92, 0xffff0000, v104
    v_and_b32 v93, 0xffff0000, v105
    v_and_b32 v94, 0xffff0000, v106
    v_and_b32 v95, 0xffff0000, v107
    v_sub_f32 v80, v80, v88
    v_sub_f32 v81, v81, v89
    v_sub_f32 v82, v82, v90
    v_sub_f32 v83, v83, v91
    v_sub_f32 v84, v84, v92
    v_sub_f32 v85, v85, v93
    v_sub_f32 v86, v86, v94
    v_sub_f32 v87, v87, v95
    v_cvt_pk_bf16_f32 v24, v80, v84
    v_cvt_pk_bf16_f32 v25, v81, v85
    v_cvt_pk_bf16_f32 v26, v82, v86
    v_cvt_pk_bf16_f32 v27, v83, v87
    s_nop 1
    v_mfma_f32_16x16x32_bf16 v[20:23], v[104:107], v[96:99], v[20:23]
    v_mfma_f32_16x16x32_bf16 v[20:23], v[104:107], v[100:103], v[20:23]
    v_mfma_f32_16x16x32_bf16 v[20:23], v[24:27], v[96:99], v[20:23]
    v_lshlrev_b32 v88, 2, v2
    v_lshl_add_u32 v88, v3, 8, v88
    s_mul_i32 s5, s3, 3072
    v_add_u32 v88, s5, v88
    s_nop 7
    s_nop 3
    ds_write_b32 v88, v12 offset:0
    ds_write_b32 v88, v13 offset:64
    ds_write_b32 v88, v14 offset:128
    ds_write_b32 v88, v15 offset:192
    ds_write_b32 v88, v16 offset:1024
    ds_write_b32 v88, v17 offset:1088
    ds_write_b32 v88, v18 offset:1152
    ds_write_b32 v88, v19 offset:1216
    ds_write_b32 v88, v20 offset:2048
    ds_write_b32 v88, v21 offset:2112
    ds_write_b32 v88, v22 offset:2176
    ds_write_b32 v88, v23 offset:2240
    s_waitcnt lgkmcnt(0)
    s_barrier
    ds_read_b32 v64, v110 offset:0
    ds_read_b32 v65, v111 offset:0
    ds_read_b32 v66, v112 offset:0
    ds_read_b32 v67, v113 offset:0
    ds_read_b32 v68, v114 offset:0
    ds_read_b32 v69, v115 offset:0
    ds_read_b32 v70, v116 offset:0
    ds_read_b32 v71, v117 offset:0
    s_waitcnt lgkmcnt(7)
    ds_read_b32 v72, v110 offset:3072
    ds_read_b32 v73, v111 offset:3072
    ds_read_b32 v74, v112 offset:3072
    ds_read_b32 v75, v113 offset:3072
    ds_read_b32 v76, v114 offset:3072
    ds_read_b32 v77, v115 offset:3072
    ds_read_b32 v78, v116 offset:3072
    ds_read_b32 v79, v117 offset:3072
    s_waitcnt lgkmcnt(7)
    ds_read_b32 v80, v110 offset:6144
    ds_read_b32 v81, v111 offset:6144
    ds_read_b32 v82, v112 offset:6144
    ds_read_b32 v83, v113 offset:6144
    ds_read_b32 v84, v114 offset:6144
    ds_read_b32 v85, v115 offset:6144
    ds_read_b32 v86, v116 offset:6144
    ds_read_b32 v87, v117 offset:6144
    s_waitcnt lgkmcnt(7)
    ds_read_b32 v88, v110 offset:9216
    ds_read_b32 v89, v111 offset:9216
    ds_read_b32 v90, v112 offset:9216
    ds_read_b32 v91, v113 offset:9216
    ds_read_b32 v92, v114 offset:9216
    ds_read_b32 v93, v115 offset:9216
    ds_read_b32 v94, v116 offset:9216
    ds_read_b32 v95, v117 offset:9216
    s_waitcnt lgkmcnt(0)
    v_add_f32 v64, v64, v72
    v_add_f32 v65, v65, v73
    v_add_f32 v66, v66, v74
    v_add_f32 v67, v67, v75
    v_add_f32 v68, v68, v76
    v_add_f32 v69, v69, v77
    v_add_f32 v70, v70, v78
    v_add_f32 v71, v71, v79
    v_add_f32 v80, v80, v88
    v_add_f32 v81, v81, v89
    v_add_f32 v82, v82, v90
    v_add_f32 v83, v83, v91
    v_add_f32 v84, v84, v92
    v_add_f32 v85, v85, v93
    v_add_f32 v86, v86, v94
    v_add_f32 v87, v87, v95
    v_add_f32 v64, v64, v80
    v_add_f32 v65, v65, v81
    v_add_f32 v66, v66, v82
    v_add_f32 v67, v67, v83
    v_add_f32 v68, v68, v84
    v_add_f32 v69, v69, v85
    v_add_f32 v70, v70, v86
    v_add_f32 v71, v71, v87
    v_cvt_pk_bf16_f32 v96, v64, v65
    v_cvt_pk_bf16_f32 v97, v66, v67
    v_cvt_pk_bf16_f32 v98, v68, v69
    v_cvt_pk_bf16_f32 v99, v70, v71
    v_lshlrev_b32 v72, 16, v96
    v_and_b32 v73, 0xffff0000, v96
    v_lshlrev_b32 v74, 16, v97
    v_and_b32 v75, 0xffff0000, v97
    v_lshlrev_b32 v76, 16, v98
    v_and_b32 v77, 0xffff0000, v98
    v_lshlrev_b32 v78, 16, v99
    v_and_b32 v79, 0xffff0000, v99
    v_sub_f32 v64, v64, v72
    v_sub_f32 v65, v65, v73
    v_sub_f32 v66, v66, v74
    v_sub_f32 v67, v67, v75
    v_sub_f32 v68, v68, v76
    v_sub_f32 v69, v69, v77
    v_sub_f32 v70, v70, v78
    v_sub_f32 v71, v71, v79
    v_cvt_pk_bf16_f32 v100, v64, v65
    v_cvt_pk_bf16_f32 v101, v66, v67
    v_cvt_pk_bf16_f32 v102, v68, v69
    v_cvt_pk_bf16_f32 v103, v70, v71
    v_lshlrev_b32 v24, 4, v0
    s_mul_i32 s5, s4, 9216
    s_add_u32 s5, s5, 0x9e4000
    s_add_u32 s6, s5, 4608
    buffer_store_dwordx4 v[96:99], v24, s[8:11], s5 offen sc1
    buffer_store_dwordx4 v[100:103], v24, s[8:11], s6 offen sc1
    s_cmp_lg_u32 s3, 0
    s_cbranch_scc1 L_kgen_end
    v_mov_b32 v104, 0
    v_mov_b32 v105, 0
    v_mov_b32 v106, 0
    v_mov_b32 v107, 0
    s_mov_b64 exec, 0xffffffff
    s_add_u32 s5, s5, 4096
    s_add_u32 s6, s6, 4096
    buffer_store_dwordx4 v[104:107], v24, s[8:11], s5 offen sc1
    buffer_store_dwordx4 v[104:107], v24, s[8:11], s6 offen sc1
    s_mov_b64 exec, -1
L_kgen_end:
    s_endpgm
.globl mid_kernel
.p2align 8
.type mid_kernel,@function
mid_kernel:
    s_load_dwordx16 s[16:31], s[0:1], 0
    s_load_dwordx16 s[32:47], s[0:1], 64
    v_lshrrev_b32 v1, 6, v0
    s_nop 0
    v_readfirstlane_b32 s3, v1
    v_and_b32 v1, 63, v0
    s_waitcnt lgkmcnt(0)
    s_mov_b32 s8, s46
    s_and_b32 s9, s47, 0xffff
    s_mov_b32 s10, 0x1694000
    s_mov_b32 s11, 0x20000
    s_cmp_lt_u32 s2, 224
    s_cbranch_scc1 L_conv
    s_cmp_lt_u32 s2, 448
    s_cbranch_scc1 L_g1
L_m_end:
    s_endpgm
L_g1:
    s_setprio 2
    s_and_b32 s4, s2, 7
    s_lshr_b32 s5, s2, 3
    s_sub_u32 s5, s5, 28
    s_mul_i32 s6, s5, 9363
    s_lshr_b32 s6, s6, 16
    s_mul_i32 s7, s6, 7
    s_sub_u32 s5, s5, s7
    s_and_b32 s7, s4, 1
    s_mul_i32 s7, s7, 7
    s_add_u32 s5, s5, s7
    s_lshr_b32 s4, s4, 1
    s_lshl_b32 s4, s4, 2
    s_add_u32 s4, s4, s6
    s_and_b32 s48, s3, 3
    s_lshr_b32 s49, s3, 2
    s_lshl_b32 s5, s5, 2
    s_add_u32 s5, s5, s48
    s_mul_i32 s12, s5, 57344
    s_add_u32 s12, s12, 0x54c000
    s_lshl_b32 s7, s49, 10
    s_add_u32 s12, s12, s7
    s_lshl_b32 s6, s4, 2
    s_add_u32 s6, s6, s48
    s_mul_i32 s13, s6, 28672
    s_mul_i32 s7, s49, 3072
    s_add_u32 s13, s13, s7
    s_mul_i32 s14, s48, 7168
    s_add_u32 s14, s14, s7
    v_lshlrev_b32 v2, 4, v1
    s_add_u32 s15, s14, 0
    s_mov_b32 m0, s15
    s_nop 0
    buffer_load_dwordx4 v2, s[8:11], s13 offen offset:0 lds
    buffer_load_dwordx4 v2, s[8:11], s13 offen offset:1024 lds
    buffer_load_dwordx4 v2, s[8:11], s13 offen offset:2048 lds
    buffer_load_dwordx4 v2, s[8:11], s13 offen offset:3072 lds
    s_add_u32 s13, s13, 7168
    buffer_load_dwordx4 v[112:115], v2, s[8:11], s12 offen offset:0
    buffer_load_dwordx4 v[116:119], v2, s[8:11], s12 offen offset:2048
    s_add_u32 s12, s12, 4096
    buffer_load_dwordx4 v[120:123], v2, s[8:11], s12 offen offset:0
    buffer_load_dwordx4 v[124:127], v2, s[8:11], s12 offen offset:2048
    s_add_u32 s12, s12, 4096
    s_add_u32 s15, s14, 28672
    s_mov_b32 m0, s15
    s_nop 0
    buffer_load_dwordx4 v2, s[8:11], s13 offen offset:0 lds
    buffer_load_dwordx4 v2, s[8:11], s13 offen offset:1024 lds
    buffer_load_dwordx4 v2, s[8:11], s13 offen offset:2048 lds
    buffer_load_dwordx4 v2, s[8:11], s13 offen offset:3072 lds
    s_add_u32 s13, s13, 7168
    s_waitcnt vmcnt(8)
    s_barrier
    ds_read_b128 v[80:83], v2 offset:0
    ds_read_b128 v[84:87], v2 offset:7168
    ds_read_b128 v[88:91], v2 offset:14336
    ds_read_b128 v[92:95], v2 offset:21504
    ds_read_b128 v[96:99], v2 offset:1024
    ds_read_b128 v[100:103], v2 offset:8192
    ds_read_b128 v[104:107], v2 offset:15360
    ds_read_b128 v[108:111], v2 offset:22528
    s_waitcnt vmcnt(7)
    s_waitcnt lgkmcnt(4)
    v_mfma_f32_32x32x16_bf16 v[16:31], v[112:115], v[80:83], 0
    v_mfma_f32_32x32x16_bf16 v[32:47], v[112:115], v[84:87], 0
    v_mfma_f32_32x32x16_bf16 v[48:63], v[112:115], v[88:91], 0
    v_mfma_f32_32x32x16_bf16 v[64:79], v[112:115], v[92:95], 0
    buffer_load_dwordx4 v[112:115], v2, s[8:11], s12 offen offset:0
    ds_read_b128 v[80:83], v2 offset:2048
    ds_read_b128 v[84:87], v2 offset:9216
    ds_read_b128 v[88:91], v2 offset:16384
    ds_read_b128 v[92:95], v2 offset:23552
    s_waitcnt vmcnt(7)
    s_waitcnt lgkmcnt(4)
    v_mfma_f32_32x32x16_bf16 v[16:31], v[116:119], v[96:99], v[16:31]
    v_mfma_f32_32x32x16_bf16 v[32:47], v[116:119], v[100:103], v[32:47]
    v_mfma_f32_32x32x16_bf16 v[48:63], v[116:119], v[104:107], v[48:63]
    v_mfma_f32_32x32x16_bf16 v[64:79], v[116:119], v[108:111], v[64:79]
    buffer_load_dwordx4 v[116:119], v2, s[8:11], s12 offen offset:2048
    s_add_u32 s12, s12, 4096
    ds_read_b128 v[96:99], v2 offset:3072
    ds_read_b128 v[100:103], v2 offset:10240
    ds_read_b128 v[104:107], v2 offset:17408
    ds_read_b128 v[108:111], v2 offset:24576
    s_waitcnt vmcnt(7)
    s_waitcnt lgkmcnt(4)
    v_mfma_f32_32x32x16_bf16 v[16:31], v[120:123], v[80:83], v[16:31]
    v_mfma_f32_32x32x16_bf16 v[32:47], v[120:123], v[84:87], v[32:47]
    v_mfma_f32_32x32x16_bf16 v[48:63], v[120:123], v[88:91], v[48:63]
    v_mfma_f32_32x32x16_bf16 v[64:79], v[120:123], v[92:95], v[64:79]
    buffer_load_dwordx4 v[120:123], v2, s[8:11], s12 offen offset:0
    ds_read_b128 v[80:83], v2 offset:4096
    ds_read_b128 v[84:87], v2 offset:11264
    ds_read_b128 v[88:91], v2 offset:18432
    ds_read_b128 v[92:95], v2 offset:25600
    s_waitcnt vmcnt(7)
    s_waitcnt lgkmcnt(4)
    v_mfma_f32_32x32x16_bf16 v[16:31], v[124:127], v[96:99], v[16:31]
    v_mfma_f32_32x32x16_bf16 v[32:47], v[124:127], v[100:103], v[32:47]
    v_mfma_f32_32x32x16_bf16 v[48:63], v[124:127], v[104:107], v[48:63]
    v_mfma_f32_32x32x16_bf16 v[64:79], v[124:127], v[108:111], v[64:79]
    buffer_load_dwordx4 v[124:127], v2, s[8:11], s12 offen offset:2048
    s_add_u32 s12, s12, 4096
    ds_read_b128 v[96:99], v2 offset:5120
    ds_read_b128 v[100:103], v2 offset:12288
    ds_read_b128 v[104:107], v2 offset:19456
    ds_read_b128 v[108:111], v2 offset:26624
    s_waitcnt vmcnt(3)
    s_waitcnt lgkmcnt(4)
    v_mfma_f32_32x32x16_bf16 v[16:31], v[112:115], v[80:83], v[16:31]
    v_mfma_f32_32x32x16_bf16 v[32:47], v[112:115], v[84:87], v[32:47]
    v_mfma_f32_32x32x16_bf16 v[48:63], v[112:115], v[88:91], v[48:63]
    v_mfma_f32_32x32x16_bf16 v[64:79], v[112:115], v[92:95], v[64:79]
    buffer_load_dwordx4 v[112:115], v2, s[8:11], s12 offen offset:0
    ds_read_b128 v[80:83], v2 offset:6144
    ds_read_b128 v[84:87], v2 offset:13312
    ds_read_b128 v[88:91], v2 offset:20480
    ds_read_b128 v[92:95], v2 offset:27648
    s_waitcnt vmcnt(3)
    s_waitcnt lgkmcnt(4)
    v_mfma_f32_32x32x16_bf16 v[16:31], v[116:119], v[96:99], v[16:31]
    v_mfma_f32_32x32x16_bf16 v[32:47], v[116:119], v[100:103], v[32:47]
    v_mfma_f32_32x32x16_bf16 v[48:63], v[116:119], v[104:107], v[48:63]
    v_mfma_f32_32x32x16_bf16 v[64:79], v[116:119], v[108:111], v[64:79]
    buffer_load_dwordx4 v[116:119], v2, s[8:11], s12 offen offset:2048
    s_add_u32 s12, s12, 4096
    s_waitcnt vmcnt(3)
    s_waitcnt lgkmcnt(0)
    v_mfma_f32_32x32x16_bf16 v[16:31], v[120:123], v[80:83], v[16:31]
    v_mfma_f32_32x32x16_bf16 v[32:47], v[120:123], v[84:87], v[32:47]
    v_mfma_f32_32x32x16_bf16 v[48:63], v[120:123], v[88:91], v[48:63]
    v_mfma_f32_32x32x16_bf16 v[64:79], v[120:123], v[92:95], v[64:79]
    buffer_load_dwordx4 v[120:123], v2, s[8:11], s12 offen offset:0
    s_barrier
    s_add_u32 s15, s14, 0
    s_mov_b32 m0, s15
    s_nop 0
    buffer_load_dwordx4 v2, s[8:11], s13 offen offset:0 lds
    buffer_load_dwordx4 v2, s[8:11], s13 offen offset:1024 lds
    buffer_load_dwordx4 v2, s[8:11], s13 offen offset:2048 lds
    buffer_load_dwordx4 v2, s[8:11], s13 offen offset:3072 lds
    s_add_u32 s13, s13, 7168
    ds_read_b128 v[96:99], v2 offset:28672
    ds_read_b128 v[100:103], v2 offset:35840
    ds_read_b128 v[104:107], v2 offset:43008
    ds_read_b128 v[108:111], v2 offset:50176
    ds_read_b128 v[80:83], v2 offset:29696
    ds_read_b128 v[84:87], v2 offset:36864
    ds_read_b128 v[88:91], v2 offset:44032
    ds_read_b128 v[92:95], v2 offset:51200
    s_waitcnt vmcnt(7)
    s_waitcnt lgkmcnt(4)
    v_mfma_f32_32x32x16_bf16 v[16:31], v[124:127], v[96:99], v[16:31]
    v_mfma_f32_32x32x16_bf16 v[32:47], v[124:127], v[100:103], v[32:47]
    v_mfma_f32_32x32x16_bf16 v[48:63], v[124:127], v[104:107], v[48:63]
    v_mfma_f32_32x32x16_bf16 v[64:79], v[124:127], v[108:111], v[64:79]
    buffer_load_dwordx4 v[124:127], v2, s[8:11], s12 offen offset:2048
    s_add_u32 s12, s12, 4096
    ds_read_b128 v[96:99], v2 offset:30720
    ds_read_b128 v[100:103], v2 offset:37888
    ds_read_b128 v[104:107], v2 offset:45056
    ds_read_b128 v[108:111], v2 offset:52224
    s_waitcnt vmcnt(7)
    s_waitcnt lgkmcnt(4)
    v_mfma_f32_32x32x16_bf16 v[16:31], v[112:115], v[80:83], v[16:31]
    v_mfma_f32_32x32x16_bf16 v[32:47], v[112:115], v[84:87], v[32:47]
    v_mfma_f32_32x32x16_bf16 v[48:63], v[112:115], v[88:91], v[48:63]
    v_mfma_f32_32x32x16_bf16 v[64:79], v[112:115], v[92:95], v[64:79]
    buffer_load_dwordx4 v[112:115], v2, s[8:11], s12 offen offset:0
    ds_read_b128 v[80:83], v2 offset:31744
    ds_read_b128 v[84:87], v2 offset:38912
    ds_read_b128 v[88:91], v2 offset:46080
    ds_read_b128 v[92:95], v2 offset:53248
    s_waitcnt vmcnt(7)
    s_waitcnt lgkmcnt(4)
    v_mfma_f32_32x32x16_bf16 v[16:31], v[116:119], v[96:99], v[16:31]
    v_mfma_f32_32x32x16_bf16 v[32:47], v[116:119], v[100:103], v[32:47]
    v_mfma_f32_32x32x16_bf16 v[48:63], v[116:119], v[104:107], v[48:63]
    v_mfma_f32_32x32x16_bf16 v[64:79], v[116:119], v[108:111], v[64:79]
    buffer_load_dwordx4 v[116:119], v2, s[8:11], s12 offen offset:2048
    s_add_u32 s12, s12, 4096
    ds_read_b128 v[96:99], v2 offset:32768
    ds_read_b128 v[100:103], v2 offset:39936
    ds_read_b128 v[104:107], v2 offset:47104
    ds_read_b128 v[108:111], v2 offset:54272
    s_waitcnt vmcnt(7)
    s_waitcnt lgkmcnt(4)
    v_mfma_f32_32x32x16_bf16 v[16:31], v[120:123], v[80:83], v[16:31]
    v_mfma_f32_32x32x16_bf16 v[32:47], v[120:123], v[84:87], v[32:47]
    v_mfma_f32_32x32x16_bf16 v[48:63], v[120:123], v[88:91], v[48:63]
    v_mfma_f32_32x32x16_bf16 v[64:79], v[120:123], v[92:95], v[64:79]
    buffer_load_dwordx4 v[120:123], v2, s[8:11], s12 offen offset:0
    ds_read_b128 v[80:83], v2 offset:33792
    ds_read_b128 v[84:87], v2 offset:40960
    ds_read_b128 v[88:91], v2 offset:48128
    ds_read_b128 v[92:95], v2 offset:55296
    s_waitcnt vmcnt(3)
    s_waitcnt lgkmcnt(4)
    v_mfma_f32_32x32x16_bf16 v[16:31], v[124:127], v[96:99], v[16:31]
    v_mfma_f32_32x32x16_bf16 v[32:47], v[124:127], v[100:103], v[32:47]
    v_mfma_f32_32x32x16_bf16 v[48:63], v[124:127], v[104:107], v[48:63]
    v_mfma_f32_32x32x16_bf16 v[64:79], v[124:127], v[108:111], v[64:79]
    buffer_load_dwordx4 v[124:127], v2, s[8:11], s12 offen offset:2048
    s_add_u32 s12, s12, 4096
    ds_read_b128 v[96:99], v2 offset:34816
    ds_read_b128 v[100:103], v2 offset:41984
    ds_read_b128 v[104:107], v2 offset:49152
    ds_read_b128 v[108:111], v2 offset:56320
    s_waitcnt vmcnt(3)
    s_waitcnt lgkmcnt(4)
    v_mfma_f32_32x32x16_bf16 v[16:31], v[112:115], v[80:83], v[16:31]
    v_mfma_f32_32x32x16_bf16 v[32:47], v[112:115], v[84:87], v[32:47]
    v_mfma_f32_32x32x16_bf16 v[48:63], v[112:115], v[88:91], v[48:63]
    v_mfma_f32_32x32x16_bf16 v[64:79], v[112:115], v[92:95], v[64:79]
    buffer_load_dwordx4 v[112:115], v2, s[8:11], s12 offen offset:0
    s_waitcnt vmcnt(3)
    s_waitcnt lgkmcnt(0)
    v_mfma_f32_32x32x16_bf16 v[16:31], v[116:119], v[96:99], v[16:31]
    v_mfma_f32_32x32x16_bf16 v[32:47], v[116:119], v[100:103], v[32:47]
    v_mfma_f32_32x32x16_bf16 v[48:63], v[116:119], v[104:107], v[48:63]
    v_mfma_f32_32x32x16_bf16 v[64:79], v[116:119], v[108:111], v[64:79]
    buffer_load_dwordx4 v[116:119], v2, s[8:11], s12 offen offset:2048
    s_add_u32 s12, s12, 4096
    s_barrier
    s_add_u32 s15, s14, 28672
    s_mov_b32 m0, s15
    s_nop 0
    buffer_load_dwordx4 v2, s[8:11], s13 offen offset:0 lds
    buffer_load_dwordx4 v2, s[8:11], s13 offen offset:1024 lds
    buffer_load_dwordx4 v2, s[8:11], s13 offen offset:2048 lds
    buffer_load_dwordx4 v2, s[8:11], s13 offen offset:3072 lds
    s_add_u32 s13, s13, 7168
    ds_read_b128 v[80:83], v2 offset:0
    ds_read_b128 v[84:87], v2 offset:7168
    ds_read_b128 v[88:91], v2 offset:14336
    ds_read_b128 v[92:95], v2 offset:21504
    ds_read_b128 v[96:99], v2 offset:1024
    ds_read_b128 v[100:103], v2 offset:8192
    ds_read_b128 v[104:107], v2 offset:15360
    ds_read_b128 v[108:111], v2 offset:22528
    s_waitcnt vmcnt(7)
    s_waitcnt lgkmcnt(4)
    v_mfma_f32_32x32x16_bf16 v[16:31], v[120:123], v[80:83], v[16:31]
    v_mfma_f32_32x32x16_bf16 v[32:47], v[120:123], v[84:87], v[32:47]
    v_mfma_f32_32x32x16_bf16 v[48:63], v[120:123], v[88:91], v[48:63]
    v_mfma_f32_32x32x16_bf16 v[64:79], v[120:123], v[92:95], v[64:79]
    buffer_load_dwordx4 v[120:123], v2, s[8:11], s12 offen offset:0
    ds_read_b128 v[80:83], v2 offset:2048
    ds_read_b128 v[84:87], v2 offset:9216
    ds_read_b128 v[88:91], v2 offset:16384
    ds_read_b128 v[92:95], v2 offset:23552
    s_waitcnt vmcnt(7)
    s_waitcnt lgkmcnt(4)
    v_mfma_f32_32x32x16_bf16 v[16:31], v[124:127], v[96:99], v[16:31]
    v_mfma_f32_32x32x16_bf16 v[32:47], v[124:127], v[100:103], v[32:47]
    v_mfma_f32_32x32x16_bf16 v[48:63], v[124:127], v[104:107], v[48:63]
    v_mfma_f32_32x32x16_bf16 v[64:79], v[124:127], v[108:111], v[64:79]
    buffer_load_dwordx4 v[124:127], v2, s[8:11], s12 offen offset:2048
    s_add_u32 s12, s12, 4096
    ds_read_b128 v[96:99], v2 offset:3072
    ds_read_b128 v[100:103], v2 offset:10240
    ds_read_b128 v[104:107], v2 offset:17408
    ds_read_b128 v[108:111], v2 offset:24576
    s_waitcnt vmcnt(7)
    s_waitcnt lgkmcnt(4)
    v_mfma_f32_32x32x16_bf16 v[16:31], v[112:115], v[80:83], v[16:31]
    v_mfma_f32_32x32x16_bf16 v[32:47], v[112:115], v[84:87], v[32:47]
    v_mfma_f32_32x32x16_bf16 v[48:63], v[112:115], v[88:91], v[48:63]
    v_mfma_f32_32x32x16_bf16 v[64:79], v[112:115], v[92:95], v[64:79]
    buffer_load_dwordx4 v[112:115], v2, s[8:11], s12 offen offset:0
    ds_read_b128 v[80:83], v2 offset:4096
    ds_read_b128 v[84:87], v2 offset:11264
    ds_read_b128 v[88:91], v2 offset:18432
    ds_read_b128 v[92:95], v2 offset:25600
    s_waitcnt vmcnt(7)
    s_waitcnt lgkmcnt(4)
    v_mfma_f32_32x32x16_bf16 v[16:31], v[116:119], v[96:99], v[16:31]
    v_mfma_f32_32x32x16_bf16 v[32:47], v[116:119], v[100:103], v[32:47]
    v_mfma_f32_32x32x16_bf16 v[48:63], v[116:119], v[104:107], v[48:63]
    v_mfma_f32_32x32x16_bf16 v[64:79], v[116:119], v[108:111], v[64:79]
    buffer_load_dwordx4 v[116:119], v2, s[8:11], s12 offen offset:2048
    s_add_u32 s12, s12, 4096
    ds_read_b128 v[96:99], v2 offset:5120
    ds_read_b128 v[100:103], v2 offset:12288
    ds_read_b128 v[104:107], v2 offset:19456
    ds_read_b128 v[108:111], v2 offset:26624
    s_waitcnt vmcnt(3)
    s_waitcnt lgkmcnt(4)
    v_mfma_f32_32x32x16_bf16 v[16:31], v[120:123], v[80:83], v[16:31]
    v_mfma_f32_32x32x16_bf16 v[32:47], v[120:123], v[84:87], v[32:47]
    v_mfma_f32_32x32x16_bf16 v[48:63], v[120:123], v[88:91], v[48:63]
    v_mfma_f32_32x32x16_bf16 v[64:79], v[120:123], v[92:95], v[64:79]
    buffer_load_dwordx4 v[120:123], v2, s[8:11], s12 offen offset:0
    ds_read_b128 v[80:83], v2 offset:6144
    ds_read_b128 v[84:87], v2 offset:13312
    ds_read_b128 v[88:91], v2 offset:20480
    ds_read_b128 v[92:95], v2 offset:27648
    s_waitcnt vmcnt(3)
    s_waitcnt lgkmcnt(4)
    v_mfma_f32_32x32x16_bf16 v[16:31], v[124:127], v[96:99], v[16:31]
    v_mfma_f32_32x32x16_bf16 v[32:47], v[124:127], v[100:103], v[32:47]
    v_mfma_f32_32x32x16_bf16 v[48:63], v[124:127], v[104:107], v[48:63]
    v_mfma_f32_32x32x16_bf16 v[64:79], v[124:127], v[108:111], v[64:79]
    buffer_load_dwordx4 v[124:127], v2, s[8:11], s12 offen offset:2048
    s_add_u32 s12, s12, 4096
    s_waitcnt vmcnt(3)
    s_waitcnt lgkmcnt(0)
    v_mfma_f32_32x32x16_bf16 v[16:31], v[112:115], v[80:83], v[16:31]
    v_mfma_f32_32x32x16_bf16 v[32:47], v[112:115], v[84:87], v[32:47]
    v_mfma_f32_32x32x16_bf16 v[48:63], v[112:115], v[88:91], v[48:63]
    v_mfma_f32_32x32x16_bf16 v[64:79], v[112:115], v[92:95], v[64:79]
    buffer_load_dwordx4 v[112:115], v2, s[8:11], s12 offen offset:0
    s_barrier
    ds_read_b128 v[96:99], v2 offset:28672
    ds_read_b128 v[100:103], v2 offset:35840
    ds_read_b128 v[104:107], v2 offset:43008
    ds_read_b128 v[108:111], v2 offset:50176
    ds_read_b128 v[80:83], v2 offset:29696
    ds_read_b128 v[84:87], v2 offset:36864
    ds_read_b128 v[88:91], v2 offset:44032
    ds_read_b128 v[92:95], v2 offset:51200
    s_waitcnt vmcnt(3)
    s_waitcnt lgkmcnt(4)
    v_mfma_f32_32x32x16_bf16 v[16:31], v[116:119], v[96:99], v[16:31]
    v_mfma_f32_32x32x16_bf16 v[32:47], v[116:119], v[100:103], v[32:47]
    v_mfma_f32_32x32x16_bf16 v[48:63], v[116:119], v[104:107], v[48:63]
    v_mfma_f32_32x32x16_bf16 v[64:79], v[116:119], v[108:111], v[64:79]
    buffer_load_dwordx4 v[116:119], v2, s[8:11], s12 offen offset:2048
    s_add_u32 s12, s12, 4096
    ds_read_b128 v[96:99], v2 offset:30720
    ds_read_b128 v[100:103], v2 offset:37888
    ds_read_b128 v[104:107], v2 offset:45056
    ds_read_b128 v[108:111], v2 offset:52224
    s_waitcnt vmcnt(3)
    s_waitcnt lgkmcnt(4)
    v_mfma_f32_32x32x16_bf16 v[16:31], v[120:123], v[80:83], v[16:31]
    v_mfma_f32_32x32x16_bf16 v[32:47], v[120:123], v[84:87], v[32:47]
    v_mfma_f32_32x32x16_bf16 v[48:63], v[120:123], v[88:91], v[48:63]
    v_mfma_f32_32x32x16_bf16 v[64:79], v[120:123], v[92:95], v[64:79]
    buffer_load_dwordx4 v[120:123], v2, s[8:11], s12 offen offset:0
    ds_read_b128 v[80:83], v2 offset:31744
    ds_read_b128 v[84:87], v2 offset:38912
    ds_read_b128 v[88:91], v2 offset:46080
    ds_read_b128 v[92:95], v2 offset:53248
    s_waitcnt vmcnt(3)
    s_waitcnt lgkmcnt(4)
    v_mfma_f32_32x32x16_bf16 v[16:31], v[124:127], v[96:99], v[16:31]
    v_mfma_f32_32x32x16_bf16 v[32:47], v[124:127], v[100:103], v[32:47]
    v_mfma_f32_32x32x16_bf16 v[48:63], v[124:127], v[104:107], v[48:63]
    v_mfma_f32_32x32x16_bf16 v[64:79], v[124:127], v[108:111], v[64:79]
    buffer_load_dwordx4 v[124:127], v2, s[8:11], s12 offen offset:2048
    s_add_u32 s12, s12, 4096
    ds_read_b128 v[96:99], v2 offset:32768
    ds_read_b128 v[100:103], v2 offset:39936
    ds_read_b128 v[104:107], v2 offset:47104
    ds_read_b128 v[108:111], v2 offset:54272
    s_waitcnt vmcnt(3)
    s_waitcnt lgkmcnt(4)
    v_mfma_f32_32x32x16_bf16 v[16:31], v[112:115], v[80:83], v[16:31]
    v_mfma_f32_32x32x16_bf16 v[32:47], v[112:115], v[84:87], v[32:47]
    v_mfma_f32_32x32x16_bf16 v[48:63], v[112:115], v[88:91], v[48:63]
    v_mfma_f32_32x32x16_bf16 v[64:79], v[112:115], v[92:95], v[64:79]
    ds_read_b128 v[80:83], v2 offset:33792
    ds_read_b128 v[84:87], v2 offset:40960
    ds_read_b128 v[88:91], v2 offset:48128
    ds_read_b128 v[92:95], v2 offset:55296
    s_waitcnt vmcnt(2)
    s_waitcnt lgkmcnt(4)
    v_mfma_f32_32x32x16_bf16 v[16:31], v[116:119], v[96:99], v[16:31]
    v_mfma_f32_32x32x16_bf16 v[32:47], v[116:119], v[100:103], v[32:47]
    v_mfma_f32_32x32x16_bf16 v[48:63], v[116:119], v[104:107], v[48:63]
    v_mfma_f32_32x32x16_bf16 v[64:79], v[116:119], v[108:111], v[64:79]
    ds_read_b128 v[96:99], v2 offset:34816
    ds_read_b128 v[100:103], v2 offset:41984
    ds_read_b128 v[104:107], v2 offset:49152
    ds_read_b128 v[108:111], v2 offset:56320
    s_waitcnt vmcnt(1)
    s_waitcnt lgkmcnt(4)
    v_mfma_f32_32x32x16_bf16 v[16:31], v[120:123], v[80:83], v[16:31]
    v_mfma_f32_32x32x16_bf16 v[32:47], v[120:123], v[84:87], v[32:47]
    v_mfma_f32_32x32x16_bf16 v[48:63], v[120:123], v[88:91], v[48:63]
    v_mfma_f32_32x32x16_bf16 v[64:79], v[120:123], v[92:95], v[64:79]
    s_waitcnt vmcnt(0)
    s_waitcnt lgkmcnt(0)
    v_mfma_f32_32x32x16_bf16 v[16:31], v[124:127], v[96:99], v[16:31]
    v_mfma_f32_32x32x16_bf16 v[32:47], v[124:127], v[100:103], v[32:47]
    v_mfma_f32_32x32x16_bf16 v[48:63], v[124:127], v[104:107], v[48:63]
    v_mfma_f32_32x32x16_bf16 v[64:79], v[124:127], v[108:111], v[64:79]
    s_nop 15
    s_nop 3
    v_cvt_pk_bf16_f32 v80, v16, v17
    v_cvt_pk_bf16_f32 v81, v18, v19
    v_cvt_pk_bf16_f32 v82, v20, v21
    v_cvt_pk_bf16_f32 v83, v22, v23
    v_cvt_pk_bf16_f32 v84, v24, v25
    v_cvt_pk_bf16_f32 v85, v26, v27
    v_cvt_pk_bf16_f32 v86, v28, v29
    v_cvt_pk_bf16_f32 v87, v30, v31
    v_cvt_pk_bf16_f32 v88, v32, v33
    v_cvt_pk_bf16_f32 v89, v34, v35
    v_cvt_pk_bf16_f32 v90, v36, v37
    v_cvt_pk_bf16_f32 v91, v38, v39
    v_cvt_pk_bf16_f32 v92, v40, v41
    v_cvt_pk_bf16_f32 v93, v42, v43
    v_cvt_pk_bf16_f32 v94, v44, v45
    v_cvt_pk_bf16_f32 v95, v46, v47
    v_cvt_pk_bf16_f32 v96, v48, v49
    v_cvt_pk_bf16_f32 v97, v50, v51
    v_cvt_pk_bf16_f32 v98, v52, v53
    v_cvt_pk_bf16_f32 v99, v54, v55
    v_cvt_pk_bf16_f32 v100, v56, v57
    v_cvt_pk_bf16_f32 v101, v58, v59
    v_cvt_pk_bf16_f32 v102, v60, v61
    v_cvt_pk_bf16_f32 v103, v62, v63
    v_cvt_pk_bf16_f32 v104, v64, v65
    v_cvt_pk_bf16_f32 v105, v66, v67
    v_cvt_pk_bf16_f32 v106, v68, v69
    v_cvt_pk_bf16_f32 v107, v70, v71
    v_cvt_pk_bf16_f32 v108, v72, v73
    v_cvt_pk_bf16_f32 v109, v74, v75
    v_cvt_pk_bf16_f32 v110, v76, v77
    v_cvt_pk_bf16_f32 v111, v78, v79
    s_lshl_b32 s6, s48, 13
    s_lshl_b32 s7, s49, 12
    s_add_u32 s6, s6, s7
    v_add_u32 v3, s6, v2
    s_xor_b32 s6, s6, 4096
    v_add_u32 v4, s6, v2
    s_barrier
    s_cmp_eq_u32 s49, 0
    s_cbranch_scc1 L_g1_e0
    ds_write_b128 v3, v[80:83] offset:0
    ds_write_b128 v3, v[84:87] offset:1024
    ds_write_b128 v3, v[88:91] offset:2048
    ds_write_b128 v3, v[92:95] offset:3072
    s_waitcnt lgkmcnt(0)
    v_mov_b32 v80, v96
    v_mov_b32 v81, v97
    v_mov_b32 v82, v98
    v_mov_b32 v83, v99
    v_mov_b32 v84, v100
    v_mov_b32 v85, v101
    v_mov_b32 v86, v102
    v_mov_b32 v87, v103
    v_mov_b32 v88, v104
    v_mov_b32 v89, v105
    v_mov_b32 v90, v106
    v_mov_b32 v91, v107
    v_mov_b32 v92, v108
    v_mov_b32 v93, v109
    v_mov_b32 v94, v110
    v_mov_b32 v95, v111
    s_branch L_g1_e1
L_g1_e0:
    ds_write_b128 v3, v[96:99] offset:0
    ds_write_b128 v3, v[100:103] offset:1024
    ds_write_b128 v3, v[104:107] offset:2048
    ds_write_b128 v3, v[108:111] offset:3072
L_g1_e1:
    s_waitcnt lgkmcnt(0)
    s_barrier
    ds_read_b128 v[96:99], v4 offset:0
    ds_read_b128 v[100:103], v4 offset:1024
    ds_read_b128 v[104:107], v4 offset:2048
    ds_read_b128 v[108:111], v4 offset:3072
    s_mul_i32 s6, s4, 458752
    s_lshl_b32 s7, s5, 11
    s_add_u32 s6, s6, s7
    s_mul_i32 s7, s49, 229376
    s_add_u32 s6, s6, s7
    s_add_u32 s6, s6, 0xdd4000
    s_waitcnt lgkmcnt(0)
    v_lshlrev_b32 v16, 16, v80
    v_and_b32 v17, 0xffff0000, v80
    v_lshlrev_b32 v24, 16, v96
    v_and_b32 v25, 0xffff0000, v96
    v_lshlrev_b32 v18, 16, v81
    v_and_b32 v19, 0xffff0000, v81
    v_lshlrev_b32 v26, 16, v97
    v_and_b32 v27, 0xffff0000, v97
    v_lshlrev_b32 v20, 16, v82
    v_and_b32 v21, 0xffff0000, v82
    v_lshlrev_b32 v28, 16, v98
    v_and_b32 v29, 0xffff0000, v98
    v_lshlrev_b32 v22, 16, v83
    v_and_b32 v23, 0xffff0000, v83
    v_lshlrev_b32 v30, 16, v99
    v_and_b32 v31, 0xffff0000, v99
    v_mul_f32 v16, v16, v24
    v_mul_f32 v17, v17, v25
    v_mul_f32 v18, v18, v26
    v_mul_f32 v19, v19, v27
    v_mul_f32 v20, v20, v28
    v_mul_f32 v21, v21, v29
    v_mul_f32 v22, v22, v30
    v_mul_f32 v23, v23, v31
    v_cvt_pk_bf16_f32 v32, v16, v17
    v_cvt_pk_bf16_f32 v33, v18, v19
    v_cvt_pk_bf16_f32 v34, v20, v21
    v_cvt_pk_bf16_f32 v35, v22, v23
    buffer_store_dwordx4 v[32:35], v2, s[8:11], s6 offen offset:0 sc1
    v_lshlrev_b32 v16, 16, v84
    v_and_b32 v17, 0xffff0000, v84
    v_lshlrev_b32 v24, 16, v100
    v_and_b32 v25, 0xffff0000, v100
    v_lshlrev_b32 v18, 16, v85
    v_and_b32 v19, 0xffff0000, v85
    v_lshlrev_b32 v26, 16, v101
    v_and_b32 v27, 0xffff0000, v101
    v_lshlrev_b32 v20, 16, v86
    v_and_b32 v21, 0xffff0000, v86
    v_lshlrev_b32 v28, 16, v102
    v_and_b32 v29, 0xffff0000, v102
    v_lshlrev_b32 v22, 16, v87
    v_and_b32 v23, 0xffff0000, v87
    v_lshlrev_b32 v30, 16, v103
    v_and_b32 v31, 0xffff0000, v103
    v_mul_f32 v16, v16, v24
    v_mul_f32 v17, v17, v25
    v_mul_f32 v18, v18, v26
    v_mul_f32 v19, v19, v27
    v_mul_f32 v20, v20, v28
    v_mul_f32 v21, v21, v29
    v_mul_f32 v22, v22, v30
    v_mul_f32 v23, v23, v31
    v_cvt_pk_bf16_f32 v36, v16, v17
    v_cvt_pk_bf16_f32 v37, v18, v19
    v_cvt_pk_bf16_f32 v38, v20, v21
    v_cvt_pk_bf16_f32 v39, v22, v23
    buffer_store_dwordx4 v[36:39], v2, s[8:11], s6 offen offset:1024 sc1
    s_add_u32 s6, s6, 114688
    v_lshlrev_b32 v16, 16, v88
    v_and_b32 v17, 0xffff0000, v88
    v_lshlrev_b32 v24, 16, v104
    v_and_b32 v25, 0xffff0000, v104
    v_lshlrev_b32 v18, 16, v89
    v_and_b32 v19, 0xffff0000, v89
    v_lshlrev_b32 v26, 16, v105
    v_and_b32 v27, 0xffff0000, v105
    v_lshlrev_b32 v20, 16, v90
    v_and_b32 v21, 0xffff0000, v90
    v_lshlrev_b32 v28, 16, v106
    v_and_b32 v29, 0xffff0000, v106
    v_lshlrev_b32 v22, 16, v91
    v_and_b32 v23, 0xffff0000, v91
    v_lshlrev_b32 v30, 16, v107
    v_and_b32 v31, 0xffff0000, v107
    v_mul_f32 v16, v16, v24
    v_mul_f32 v17, v17, v25
    v_mul_f32 v18, v18, v26
    v_mul_f32 v19, v19, v27
    v_mul_f32 v20, v20, v28
    v_mul_f32 v21, v21, v29
    v_mul_f32 v22, v22, v30
    v_mul_f32 v23, v23, v31
    v_cvt_pk_bf16_f32 v40, v16, v17
    v_cvt_pk_bf16_f32 v41, v18, v19
    v_cvt_pk_bf16_f32 v42, v20, v21
    v_cvt_pk_bf16_f32 v43, v22, v23
    buffer_store_dwordx4 v[40:43], v2, s[8:11], s6 offen offset:0 sc1
    v_lshlrev_b32 v16, 16, v92
    v_and_b32 v17, 0xffff0000, v92
    v_lshlrev_b32 v24, 16, v108
    v_and_b32 v25, 0xffff0000, v108
    v_lshlrev_b32 v18, 16, v93
    v_and_b32 v19, 0xffff0000, v93
    v_lshlrev_b32 v26, 16, v109
    v_and_b32 v27, 0xffff0000, v109
    v_lshlrev_b32 v20, 16, v94
    v_and_b32 v21, 0xffff0000, v94
    v_lshlrev_b32 v28, 16, v110
    v_and_b32 v29, 0xffff0000, v110
    v_lshlrev_b32 v22, 16, v95
    v_and_b32 v23, 0xffff0000, v95
    v_lshlrev_b32 v30, 16, v111
    v_and_b32 v31, 0xffff0000, v111
    v_mul_f32 v16, v16, v24
    v_mul_f32 v17, v17, v25
    v_mul_f32 v18, v18, v26
    v_mul_f32 v19, v19, v27
    v_mul_f32 v20, v20, v28
    v_mul_f32 v21, v21, v29
    v_mul_f32 v22, v22, v30
    v_mul_f32 v23, v23, v31
    v_cvt_pk_bf16_f32 v44, v16, v17
    v_cvt_pk_bf16_f32 v45, v18, v19
    v_cvt_pk_bf16_f32 v46, v20, v21
    v_cvt_pk_bf16_f32 v47, v22, v23
    buffer_store_dwordx4 v[44:47], v2, s[8:11], s6 offen offset:1024 sc1
    s_endpgm
L_conv:
    s_and_b32 s48, s3, 3
    s_lshr_b32 s49, s3, 2
    s_lshl_b32 s4, s2, 1
    s_add_u32 s4, s4, s49
    s_lshl_b32 s50, s49, 15
    v_lshlrev_b32 v5, 4, v1
    v_and_b32 v2, 255, v0
    v_lshrrev_b32 v11, 1, v2
    v_lshlrev_b32 v11, 6, v11
    v_add_u32 v11, s50, v11
    v_bfe_u32 v12, v2, 2, 2
    v_and_b32 v13, 1, v2
    v_lshlrev_b32 v13, 1, v13
    v_xor_b32 v12, v12, v13
    v_xor_b32 v13, 1, v12
    v_lshl_add_u32 v4, v13, 4, v11
    v_lshl_add_u32 v11, v12, 4, v11
    v_lshlrev_b32 v2, 4, v2
    v_lshrrev_b32 v8, 5, v0
    v_mul_u32_u24 v8, 28672, v8
    v_and_b32 v12, 31, v0
    v_lshl_add_u32 v8, v12, 4, v8
    s_and_b32 s5, s4, 0x1fe
    s_lshr_b32 s6, s5, 4
    s_lshl_b32 s6, s6, 10
    s_bfe_u32 s7, s5, 0x10003
    s_lshl_b32 s7, s7, 9
    s_add_u32 s6, s6, s7
    s_and_b32 s7, s5, 7
    s_lshl_b32 s7, s7, 1
    s_add_u32 s6, s6, s7
    buffer_load_dword v16, v8, s[8:11], s6 offen
    s_add_u32 s6, s6, 458752
    buffer_load_dword v17, v8, s[8:11], s6 offen
    s_add_u32 s6, s6, 458752
    buffer_load_dword v18, v8, s[8:11], s6 offen
    s_add_u32 s6, s6, 458752
    buffer_load_dword v19, v8, s[8:11], s6 offen
    v_lshlrev_b32 v3, 1, v0
    s_mul_i32 s5, s4, 9216
    s_add_u32 s5, s5, 0x9e4000
    s_lshl_b32 s6, s48, 11
    s_add_u32 s5, s5, s6
    s_add_u32 s6, s6, 20544
    s_add_u32 s6, s6, s50
    s_mov_b32 m0, s6
    s_nop 0
    buffer_load_dwordx4 v5, s[8:11], s5 offen lds
    buffer_load_dwordx4 v5, s[8:11], s5 offen offset:1024 lds
    s_cmp_lg_u32 s48, 0
    s_cbranch_scc1 L_conv_k9
    s_add_u32 s5, s5, 8192
    s_add_u32 s6, s50, 28736
    s_mov_b32 m0, s6
    s_nop 0
    buffer_load_dwordx4 v5, s[8:11], s5 offen lds
L_conv_k9:
    s_cmp_lg_u32 s3, 0
    s_cbranch_scc1 L_conv_nz
    v_mov_b32 v12, 0
    v_mov_b32 v13, 0
    v_mov_b32 v14, 0
    v_mov_b32 v15, 0
    v_and_b32 v8, 3, v1
    v_mul_u32_u24 v8, 5136, v8
    v_bfe_u32 v20, v1, 2, 1
    v_lshl_add_u32 v8, v20, 4, v8
    v_bfe_u32 v20, v1, 3, 1
    v_lshl_add_u32 v8, v20, 15, v8
    s_mov_b64 exec, 0xffff
    ds_write_b128 v8, v[12:15]
    s_mov_b64 exec, -1
L_conv_nz:
    s_waitcnt vmcnt(2)
    ds_write_b16 v3, v16 offset:30
    ds_write_b16_d16_hi v3, v16 offset:32798
    ds_write_b16 v3, v16 offset:5164
    ds_write_b16_d16_hi v3, v16 offset:37932
    ds_write_b16 v3, v16 offset:10298
    ds_write_b16_d16_hi v3, v16 offset:43066
    ds_write_b16 v3, v16 offset:15432
    ds_write_b16_d16_hi v3, v16 offset:48200
    s_waitcnt lgkmcnt(4)
    ds_write_b16 v3, v17 offset:1054
    ds_write_b16_d16_hi v3, v17 offset:33822
    ds_write_b16 v3, v17 offset:6188
    ds_write_b16_d16_hi v3, v17 offset:38956
    ds_write_b16 v3, v17 offset:11322
    ds_write_b16_d16_hi v3, v17 offset:44090
    ds_write_b16 v3, v17 offset:16456
    ds_write_b16_d16_hi v3, v17 offset:49224
    s_waitcnt lgkmcnt(4)
    ds_write_b16 v3, v18 offset:2078
    ds_write_b16_d16_hi v3, v18 offset:34846
    ds_write_b16 v3, v18 offset:7212
    ds_write_b16_d16_hi v3, v18 offset:39980
    ds_write_b16 v3, v18 offset:12346
    ds_write_b16_d16_hi v3, v18 offset:45114
    ds_write_b16 v3, v18 offset:17480
    ds_write_b16_d16_hi v3, v18 offset:50248
    s_waitcnt lgkmcnt(4)
    ds_write_b16 v3, v19 offset:3102
    ds_write_b16_d16_hi v3, v19 offset:35870
    ds_write_b16 v3, v19 offset:8236
    ds_write_b16_d16_hi v3, v19 offset:41004
    ds_write_b16 v3, v19 offset:13370
    ds_write_b16_d16_hi v3, v19 offset:46138
    ds_write_b16 v3, v19 offset:18504
    ds_write_b16_d16_hi v3, v19 offset:51272
    s_waitcnt lgkmcnt(4)
    v_and_b32 v6, 3, v1
    v_mul_u32_u24 v6, 5136, v6
    v_lshrrev_b32 v7, 4, v1
    v_bfe_u32 v8, v1, 2, 2
    v_lshl_add_u32 v6, v8, 3, v6
    v_lshl_add_u32 v6, v7, 4, v6
    s_lshl_b32 s6, s48, 7
    s_add_u32 s6, s6, s50
    v_add_u32 v6, s6, v6
    v_and_b32 v8, 15, v1
    v_lshlrev_b32 v8, 5, v8
    v_lshlrev_b32 v9, 4, v7
    v_sub_u32 v9, v9, v8
    s_add_u32 s6, s6, 21024
    v_add_u32 v9, s6, v9
    v_and_b32 v10, 15, v1
    v_bfe_u32 v12, v1, 1, 2
    v_xor_b32 v12, v12, v7
    v_lshlrev_b32 v10, 6, v10
    v_lshl_add_u32 v10, v12, 4, v10
    s_lshl_b32 s6, s48, 13
    s_add_u32 s6, s6, s50
    v_add_u32 v10, s6, v10
    s_waitcnt vmcnt(0) lgkmcnt(0)
    s_barrier
    ds_read_b64 v[16:17], v6 offset:0
    ds_read_b64 v[18:19], v6 offset:8
    ds_read_b128 v[76:79], v9 offset:0
    ds_read_b128 v[72:75], v9 offset:512
    ds_read_b128 v[68:71], v9 offset:1024
    ds_read_b128 v[64:67], v9 offset:1536
    ds_read_b128 v[60:63], v9 offset:2048
    ds_read_b128 v[56:59], v9 offset:2560
    ds_read_b128 v[52:55], v9 offset:3072
    ds_read_b128 v[48:51], v9 offset:3584
    ds_read_b64 v[20:21], v6 offset:512
    ds_read_b64 v[22:23], v6 offset:520
    ds_read_b64 v[24:25], v6 offset:1024
    ds_read_b64 v[26:27], v6 offset:1032
    s_waitcnt lgkmcnt(7)
    ds_read_b64 v[28:29], v6 offset:1536
    ds_read_b64 v[30:31], v6 offset:1544
    ds_read_b64 v[32:33], v6 offset:2048
    ds_read_b64 v[34:35], v6 offset:2056
    ds_read_b64 v[36:37], v6 offset:2560
    ds_read_b64 v[38:39], v6 offset:2568
    ds_read_b64 v[40:41], v6 offset:3072
    s_waitcnt lgkmcnt(7)
    ds_read_b64 v[42:43], v6 offset:3080
    ds_read_b64 v[44:45], v6 offset:3584
    ds_read_b64 v[46:47], v6 offset:3592
    v_mfma_f32_16x16x32_bf16 v[108:111], v[16:19], v[76:79], 0
    v_mfma_f32_16x16x32_bf16 v[104:107], v[16:19], v[72:75], 0
    v_mfma_f32_16x16x32_bf16 v[100:103], v[16:19], v[68:71], 0
    v_mfma_f32_16x16x32_bf16 v[96:99], v[16:19], v[64:67], 0
    v_mfma_f32_16x16x32_bf16 v[92:95], v[16:19], v[60:63], 0
    v_mfma_f32_16x16x32_bf16 v[88:91], v[16:19], v[56:59], 0
    v_mfma_f32_16x16x32_bf16 v[84:87], v[16:19], v[52:55], 0
    v_mfma_f32_16x16x32_bf16 v[80:83], v[16:19], v[48:51], 0
    ds_read_b128 v[76:79], v9 offset:4608
    v_mfma_f32_16x16x32_bf16 v[108:111], v[20:23], v[72:75], v[108:111]
    v_mfma_f32_16x16x32_bf16 v[104:107], v[20:23], v[68:71], v[104:107]
    v_mfma_f32_16x16x32_bf16 v[100:103], v[20:23], v[64:67], v[100:103]
    v_mfma_f32_16x16x32_bf16 v[96:99], v[20:23], v[60:63], v[96:99]
    v_mfma_f32_16x16x32_bf16 v[92:95], v[20:23], v[56:59], v[92:95]
    v_mfma_f32_16x16x32_bf16 v[88:91], v[20:23], v[52:55], v[88:91]
    v_mfma_f32_16x16x32_bf16 v[84:87], v[20:23], v[48:51], v[84:87]
    ds_read_b128 v[72:75], v9 offset:5120
    v_mfma_f32_16x16x32_bf16 v[108:111], v[24:27], v[68:71], v[108:111]
    v_mfma_f32_16x16x32_bf16 v[104:107], v[24:27], v[64:67], v[104:107]
    v_mfma_f32_16x16x32_bf16 v[100:103], v[24:27], v[60:63], v[100:103]
    v_mfma_f32_16x16x32_bf16 v[96:99], v[24:27], v[56:59], v[96:99]
    v_mfma_f32_16x16x32_bf16 v[92:95], v[24:27], v[52:55], v[92:95]
    v_mfma_f32_16x16x32_bf16 v[88:91], v[24:27], v[48:51], v[88:91]
    ds_read_b128 v[68:71], v9 offset:5632
    s_waitcnt lgkmcnt(11)
    v_mfma_f32_16x16x32_bf16 v[108:111], v[28:31], v[64:67], v[108:111]
    v_mfma_f32_16x16x32_bf16 v[104:107], v[28:31], v[60:63], v[104:107]
    v_mfma_f32_16x16x32_bf16 v[100:103], v[28:31], v[56:59], v[100:103]
    v_mfma_f32_16x16x32_bf16 v[96:99], v[28:31], v[52:55], v[96:99]
    v_mfma_f32_16x16x32_bf16 v[92:95], v[28:31], v[48:51], v[92:95]
    ds_read_b128 v[64:67], v9 offset:6144
    s_waitcnt lgkmcnt(10)
    v_mfma_f32_16x16x32_bf16 v[108:111], v[32:35], v[60:63], v[108:111]
    v_mfma_f32_16x16x32_bf16 v[104:107], v[32:35], v[56:59], v[104:107]
    v_mfma_f32_16x16x32_bf16 v[100:103], v[32:35], v[52:55], v[100:103]
    v_mfma_f32_16x16x32_bf16 v[96:99], v[32:35], v[48:51], v[96:99]
    ds_read_b128 v[60:63], v9 offset:6656
    s_waitcnt lgkmcnt(9)
    v_mfma_f32_16x16x32_bf16 v[108:111], v[36:39], v[56:59], v[108:111]
    v_mfma_f32_16x16x32_bf16 v[104:107], v[36:39], v[52:55], v[104:107]
    v_mfma_f32_16x16x32_bf16 v[100:103], v[36:39], v[48:51], v[100:103]
    ds_read_b128 v[56:59], v9 offset:7168
    s_waitcnt lgkmcnt(8)
    v_mfma_f32_16x16x32_bf16 v[108:111], v[40:43], v[52:55], v[108:111]
    v_mfma_f32_16x16x32_bf16 v[104:107], v[40:43], v[48:51], v[104:107]
    ds_read_b128 v[52:55], v9 offset:7680
    s_waitcnt lgkmcnt(7)
    v_mfma_f32_16x16x32_bf16 v[108:111], v[44:47], v[48:51], v[108:111]
    ds_read_b128 v[48:51], v9 offset:8192
    s_waitcnt lgkmcnt(7)
    v_mfma_f32_16x16x32_bf16 v[108:111], v[16:19], v[76:79], v[108:111]
    s_waitcnt lgkmcnt(6)
    v_mfma_f32_16x16x32_bf16 v[104:107], v[16:19], v[72:75], v[104:107]
    s_waitcnt lgkmcnt(5)
    v_mfma_f32_16x16x32_bf16 v[100:103], v[16:19], v[68:71], v[100:103]
    s_waitcnt lgkmcnt(4)
    v_mfma_f32_16x16x32_bf16 v[96:99], v[16:19], v[64:67], v[96:99]
    s_waitcnt lgkmcnt(3)
    v_mfma_f32_16x16x32_bf16 v[92:95], v[16:19], v[60:63], v[92:95]
    s_waitcnt lgkmcnt(2)
    v_mfma_f32_16x16x32_bf16 v[88:91], v[16:19], v[56:59], v[88:91]
    s_waitcnt lgkmcnt(1)
    v_mfma_f32_16x16x32_bf16 v[84:87], v[16:19], v[52:55], v[84:87]
    s_waitcnt lgkmcnt(0)
    v_mfma_f32_16x16x32_bf16 v[80:83], v[16:19], v[48:51], v[80:83]
    ds_read_b128 v[76:79], v9 offset:64
    ds_read_b64 v[16:17], v6 offset:64
    ds_read_b64 v[18:19], v6 offset:72
    v_mfma_f32_16x16x32_bf16 v[108:111], v[20:23], v[72:75], v[108:111]
    v_mfma_f32_16x16x32_bf16 v[104:107], v[20:23], v[68:71], v[104:107]
    v_mfma_f32_16x16x32_bf16 v[100:103], v[20:23], v[64:67], v[100:103]
    v_mfma_f32_16x16x32_bf16 v[96:99], v[20:23], v[60:63], v[96:99]
    v_mfma_f32_16x16x32_bf16 v[92:95], v[20:23], v[56:59], v[92:95]
    v_mfma_f32_16x16x32_bf16 v[88:91], v[20:23], v[52:55], v[88:91]
    v_mfma_f32_16x16x32_bf16 v[84:87], v[20:23], v[48:51], v[84:87]
    ds_read_b128 v[72:75], v9 offset:576
    ds_read_b64 v[20:21], v6 offset:576
    ds_read_b64 v[22:23], v6 offset:584
    v_mfma_f32_16x16x32_bf16 v[108:111], v[24:27], v[68:71], v[108:111]
    v_mfma_f32_16x16x32_bf16 v[104:107], v[24:27], v[64:67], v[104:107]
    v_mfma_f32_16x16x32_bf16 v[100:103], v[24:27], v[60:63], v[100:103]
    v_mfma_f32_16x16x32_bf16 v[96:99], v[24:27], v[56:59], v[96:99]
    v_mfma_f32_16x16x32_bf16 v[92:95], v[24:27], v[52:55], v[92:95]
    v_mfma_f32_16x16x32_bf16 v[88:91], v[24:27], v[48:51], v[88:91]
    ds_read_b128 v[68:71], v9 offset:1088
    ds_read_b64 v[24:25], v6 offset:1088
    ds_read_b64 v[26:27], v6 offset:1096
    v_mfma_f32_16x16x32_bf16 v[108:111], v[28:31], v[64:67], v[108:111]
    v_mfma_f32_16x16x32_bf16 v[104:107], v[28:31], v[60:63], v[104:107]
    v_mfma_f32_16x16x32_bf16 v[100:103], v[28:31], v[56:59], v[100:103]
    v_mfma_f32_16x16x32_bf16 v[96:99], v[28:31], v[52:55], v[96:99]
    v_mfma_f32_16x16x32_bf16 v[92:95], v[28:31], v[48:51], v[92:95]
    ds_read_b128 v[64:67], v9 offset:1600
    ds_read_b64 v[28:29], v6 offset:1600
    ds_read_b64 v[30:31], v6 offset:1608
    v_mfma_f32_16x16x32_bf16 v[108:111], v[32:35], v[60:63], v[108:111]
    v_mfma_f32_16x16x32_bf16 v[104:107], v[32:35], v[56:59], v[104:107]
    v_mfma_f32_16x16x32_bf16 v[100:103], v[32:35], v[52:55], v[100:103]
    v_mfma_f32_16x16x32_bf16 v[96:99], v[32:35], v[48:51], v[96:99]
    ds_read_b128 v[60:63], v9 offset:2112
    ds_read_b64 v[32:33], v6 offset:2112
    s_waitcnt lgkmcnt(7)
    ds_read_b64 v[34:35], v6 offset:2120
    v_mfma_f32_16x16x32_bf16 v[108:111], v[36:39], v[56:59], v[108:111]
    v_mfma_f32_16x16x32_bf16 v[104:107], v[36:39], v[52:55], v[104:107]
    v_mfma_f32_16x16x32_bf16 v[100:103], v[36:39], v[48:51], v[100:103]
    ds_read_b128 v[56:59], v9 offset:2624
    ds_read_b64 v[36:37], v6 offset:2624
    ds_read_b64 v[38:39], v6 offset:2632
    v_mfma_f32_16x16x32_bf16 v[108:111], v[40:43], v[52:55], v[108:111]
    v_mfma_f32_16x16x32_bf16 v[104:107], v[40:43], v[48:51], v[104:107]
    ds_read_b128 v[52:55], v9 offset:3136
    ds_read_b64 v[40:41], v6 offset:3136
    ds_read_b64 v[42:43], v6 offset:3144
    v_mfma_f32_16x16x32_bf16 v[108:111], v[44:47], v[48:51], v[108:111]
    s_waitcnt lgkmcnt(7)
    ds_read_b128 v[48:51], v9 offset:3648
    ds_read_b64 v[44:45], v6 offset:3648
    ds_read_b64 v[46:47], v6 offset:3656
    v_mfma_f32_16x16x32_bf16 v[108:111], v[16:19], v[76:79], v[108:111]
    v_mfma_f32_16x16x32_bf16 v[104:107], v[16:19], v[72:75], v[104:107]
    v_mfma_f32_16x16x32_bf16 v[100:103], v[16:19], v[68:71], v[100:103]
    v_mfma_f32_16x16x32_bf16 v[96:99], v[16:19], v[64:67], v[96:99]
    v_mfma_f32_16x16x32_bf16 v[92:95], v[16:19], v[60:63], v[92:95]
    s_waitcnt lgkmcnt(8)
    v_mfma_f32_16x16x32_bf16 v[88:91], v[16:19], v[56:59], v[88:91]
    s_waitcnt lgkmcnt(5)
    v_mfma_f32_16x16x32_bf16 v[84:87], v[16:19], v[52:55], v[84:87]
    s_waitcnt lgkmcnt(2)
    v_mfma_f32_16x16x32_bf16 v[80:83], v[16:19], v[48:51], v[80:83]
    ds_read_b128 v[76:79], v9 offset:4672
    v_mfma_f32_16x16x32_bf16 v[108:111], v[20:23], v[72:75], v[108:111]
    v_mfma_f32_16x16x32_bf16 v[104:107], v[20:23], v[68:71], v[104:107]
    v_mfma_f32_16x16x32_bf16 v[100:103], v[20:23], v[64:67], v[100:103]
    v_mfma_f32_16x16x32_bf16 v[96:99], v[20:23], v[60:63], v[96:99]
    v_mfma_f32_16x16x32_bf16 v[92:95], v[20:23], v[56:59], v[92:95]
    v_mfma_f32_16x16x32_bf16 v[88:91], v[20:23], v[52:55], v[88:91]
    v_mfma_f32_16x16x32_bf16 v[84:87], v[20:23], v[48:51], v[84:87]
    ds_read_b128 v[72:75], v9 offset:5184
    v_mfma_f32_16x16x32_bf16 v[108:111], v[24:27], v[68:71], v[108:111]
    v_mfma_f32_16x16x32_bf16 v[104:107], v[24:27], v[64:67], v[104:107]
    v_mfma_f32_16x16x32_bf16 v[100:103], v[24:27], v[60:63], v[100:103]
    v_mfma_f32_16x16x32_bf16 v[96:99], v[24:27], v[56:59], v[96:99]
    v_mfma_f32_16x16x32_bf16 v[92:95], v[24:27], v[52:55], v[92:95]
    v_mfma_f32_16x16x32_bf16 v[88:91], v[24:27], v[48:51], v[88:91]
    ds_read_b128 v[68:71], v9 offset:5696
    v_mfma_f32_16x16x32_bf16 v[108:111], v[28:31], v[64:67], v[108:111]
    v_mfma_f32_16x16x32_bf16 v[104:107], v[28:31], v[60:63], v[104:107]
    v_mfma_f32_16x16x32_bf16 v[100:103], v[28:31], v[56:59], v[100:103]
    v_mfma_f32_16x16x32_bf16 v[96:99], v[28:31], v[52:55], v[96:99]
    v_mfma_f32_16x16x32_bf16 v[92:95], v[28:31], v[48:51], v[92:95]
    ds_read_b128 v[64:67], v9 offset:6208
    v_mfma_f32_16x16x32_bf16 v[108:111], v[32:35], v[60:63], v[108:111]
    v_mfma_f32_16x16x32_bf16 v[104:107], v[32:35], v[56:59], v[104:107]
    v_mfma_f32_16x16x32_bf16 v[100:103], v[32:35], v[52:55], v[100:103]
    v_mfma_f32_16x16x32_bf16 v[96:99], v[32:35], v[48:51], v[96:99]
    ds_read_b128 v[60:63], v9 offset:6720
    v_mfma_f32_16x16x32_bf16 v[108:111], v[36:39], v[56:59], v[108:111]
    v_mfma_f32_16x16x32_bf16 v[104:107], v[36:39], v[52:55], v[104:107]
    v_mfma_f32_16x16x32_bf16 v[100:103], v[36:39], v[48:51], v[100:103]
    ds_read_b128 v[56:59], v9 offset:7232
    v_mfma_f32_16x16x32_bf16 v[108:111], v[40:43], v[52:55], v[108:111]
    v_mfma_f32_16x16x32_bf16 v[104:107], v[40:43], v[48:51], v[104:107]
    ds_read_b128 v[52:55], v9 offset:7744
    s_waitcnt lgkmcnt(7)
    v_mfma_f32_16x16x32_bf16 v[108:111], v[44:47], v[48:51], v[108:111]
    ds_read_b128 v[48:51], v9 offset:8256
    s_waitcnt lgkmcnt(7)
    v_mfma_f32_16x16x32_bf16 v[108:111], v[16:19], v[76:79], v[108:111]
    s_waitcnt lgkmcnt(6)
    v_mfma_f32_16x16x32_bf16 v[104:107], v[16:19], v[72:75], v[104:107]
    s_waitcnt lgkmcnt(5)
    v_mfma_f32_16x16x32_bf16 v[100:103], v[16:19], v[68:71], v[100:103]
    s_waitcnt lgkmcnt(4)
    v_mfma_f32_16x16x32_bf16 v[96:99], v[16:19], v[64:67], v[96:99]
    s_waitcnt lgkmcnt(3)
    v_mfma_f32_16x16x32_bf16 v[92:95], v[16:19], v[60:63], v[92:95]
    s_waitcnt lgkmcnt(2)
    v_mfma_f32_16x16x32_bf16 v[88:91], v[16:19], v[56:59], v[88:91]
    s_waitcnt lgkmcnt(1)
    v_mfma_f32_16x16x32_bf16 v[84:87], v[16:19], v[52:55], v[84:87]
    s_waitcnt lgkmcnt(0)
    v_mfma_f32_16x16x32_bf16 v[80:83], v[16:19], v[48:51], v[80:83]
    v_mfma_f32_16x16x32_bf16 v[108:111], v[20:23], v[72:75], v[108:111]
    v_mfma_f32_16x16x32_bf16 v[104:107], v[20:23], v[68:71], v[104:107]
    v_mfma_f32_16x16x32_bf16 v[100:103], v[20:23], v[64:67], v[100:103]
    v_mfma_f32_16x16x32_bf16 v[96:99], v[20:23], v[60:63], v[96:99]
    v_mfma_f32_16x16x32_bf16 v[92:95], v[20:23], v[56:59], v[92:95]
    v_mfma_f32_16x16x32_bf16 v[88:91], v[20:23], v[52:55], v[88:91]
    v_mfma_f32_16x16x32_bf16 v[84:87], v[20:23], v[48:51], v[84:87]
    v_mfma_f32_16x16x32_bf16 v[108:111], v[24:27], v[68:71], v[108:111]
    v_mfma_f32_16x16x32_bf16 v[104:107], v[24:27], v[64:67], v[104:107]
    v_mfma_f32_16x16x32_bf16 v[100:103], v[24:27], v[60:63], v[100:103]
    v_mfma_f32_16x16x32_bf16 v[96:99], v[24:27], v[56:59], v[96:99]
    v_mfma_f32_16x16x32_bf16 v[92:95], v[24:27], v[52:55], v[92:95]
    v_mfma_f32_16x16x32_bf16 v[88:91], v[24:27], v[48:51], v[88:91]
    v_mfma_f32_16x16x32_bf16 v[108:111], v[28:31], v[64:67], v[108:111]
    v_mfma_f32_16x16x32_bf16 v[104:107], v[28:31], v[60:63], v[104:107]
    v_mfma_f32_16x16x32_bf16 v[100:103], v[28:31], v[56:59], v[100:103]
    v_mfma_f32_16x16x32_bf16 v[96:99], v[28:31], v[52:55], v[96:99]
    v_mfma_f32_16x16x32_bf16 v[92:95], v[28:31], v[48:51], v[92:95]
    v_mfma_f32_16x16x32_bf16 v[108:111], v[32:35], v[60:63], v[108:111]
    v_mfma_f32_16x16x32_bf16 v[104:107], v[32:35], v[56:59], v[104:107]
    v_mfma_f32_16x16x32_bf16 v[100:103], v[32:35], v[52:55], v[100:103]
    v_mfma_f32_16x16x32_bf16 v[96:99], v[32:35], v[48:51], v[96:99]
    v_mfma_f32_16x16x32_bf16 v[108:111], v[36:39], v[56:59], v[108:111]
    v_mfma_f32_16x16x32_bf16 v[104:107], v[36:39], v[52:55], v[104:107]
    v_mfma_f32_16x16x32_bf16 v[100:103], v[36:39], v[48:51], v[100:103]
    v_mfma_f32_16x16x32_bf16 v[108:111], v[40:43], v[52:55], v[108:111]
    v_mfma_f32_16x16x32_bf16 v[104:107], v[40:43], v[48:51], v[104:107]
    v_mfma_f32_16x16x32_bf16 v[108:111], v[44:47], v[48:51], v[108:111]
    s_barrier
    s_nop 7
    ds_write_b128 v10, v[80:83] offset:0
    ds_write_b128 v10, v[84:87] offset:1024
    ds_write_b128 v10, v[88:91] offset:2048
    ds_write_b128 v10, v[92:95] offset:3072
    ds_write_b128 v10, v[96:99] offset:4096
    ds_write_b128 v10, v[100:103] offset:5120
    ds_write_b128 v10, v[104:107] offset:6144
    ds_write_b128 v10, v[108:111] offset:7168
    s_waitcnt lgkmcnt(0)
    s_barrier
    ds_read_b128 v[16:19], v11 offset:0
    ds_read_b128 v[20:23], v4 offset:0
    ds_read_b128 v[24:27], v11 offset:8192
    ds_read_b128 v[28:31], v4 offset:8192
    ds_read_b128 v[32:35], v11 offset:16384
    ds_read_b128 v[36:39], v4 offset:16384
    ds_read_b128 v[40:43], v11 offset:24576
    ds_read_b128 v[44:47], v4 offset:24576
    s_waitcnt lgkmcnt(0)
    v_add_f32 v16, v16, v24
    v_add_f32 v17, v17, v25
    v_add_f32 v18, v18, v26
    v_add_f32 v19, v19, v27
    v_add_f32 v20, v20, v28
    v_add_f32 v21, v21, v29
    v_add_f32 v22, v22, v30
    v_add_f32 v23, v23, v31
    v_add_f32 v32, v32, v40
    v_add_f32 v33, v33, v41
    v_add_f32 v34, v34, v42
    v_add_f32 v35, v35, v43
    v_add_f32 v36, v36, v44
    v_add_f32 v37, v37, v45
    v_add_f32 v38, v38, v46
    v_add_f32 v39, v39, v47
    v_add_f32 v16, v16, v32
    v_add_f32 v17, v17, v33
    v_add_f32 v18, v18, v34
    v_add_f32 v19, v19, v35
    v_add_f32 v20, v20, v36
    v_add_f32 v21, v21, v37
    v_add_f32 v22, v22, v38
    v_add_f32 v23, v23, v39
    v_cvt_pk_bf16_f32 v48, v16, v17
    v_cvt_pk_bf16_f32 v49, v18, v19
    v_cvt_pk_bf16_f32 v50, v20, v21
    v_cvt_pk_bf16_f32 v51, v22, v23
    s_lshl_b32 s5, s4, 12
    s_add_u32 s5, s5, 0x14d4000
    buffer_store_dwordx4 v[48:51], v2, s[8:11], s5 offen sc1
    s_endpgm
.globl fin_kernel
.p2align 8
.type fin_kernel,@function
fin_kernel:
    s_cmp_ge_u32 s2, 224
    s_cbranch_scc1 L_fin_end
    s_load_dwordx16 s[16:31], s[0:1], 0
    s_load_dwordx16 s[32:47], s[0:1], 64
    v_lshrrev_b32 v1, 6, v0
    s_nop 0
    v_readfirstlane_b32 s3, v1
    v_and_b32 v1, 63, v0
    s_waitcnt lgkmcnt(0)
    s_mov_b32 s8, s46
    s_and_b32 s9, s47, 0xffff
    s_mov_b32 s10, 0x1694000
    s_mov_b32 s11, 0x20000
    s_and_b32 s4, s2, 7
    s_lshr_b32 s5, s2, 3
    s_mul_i32 s6, s5, 9363
    s_lshr_b32 s6, s6, 16
    s_mul_i32 s7, s6, 7
    s_sub_u32 s5, s5, s7
    s_lshl_b32 s4, s4, 2
    s_add_u32 s4, s4, s6
    v_lshlrev_b32 v2, 4, v1
    s_mul_i32 s6, s3, 14336
    s_mul_i32 s12, s5, 229376
    s_add_u32 s12, s12, s6
    s_add_u32 s12, s12, 0x85c000
    s_add_u32 s13, s12, 114688
    s_mul_i32 s14, s4, 229376
    s_add_u32 s14, s14, s6
    s_add_u32 s14, s14, 0xdd4000
    s_add_u32 s15, s14, 114688
    buffer_load_dwordx4 v[128:131], v2, s[8:11], s12 offen offset:0
    buffer_load_dwordx4 v[132:135], v2, s[8:11], s13 offen offset:0
    buffer_load_dwordx4 v[136:139], v2, s[8:11], s14 offen offset:0
    buffer_load_dwordx4 v[140:143], v2, s[8:11], s15 offen offset:0
    buffer_load_dwordx4 v[144:147], v2, s[8:11], s12 offen offset:1024
    buffer_load_dwordx4 v[148:151], v2, s[8:11], s13 offen offset:1024
    buffer_load_dwordx4 v[152:155], v2, s[8:11], s14 offen offset:1024
    buffer_load_dwordx4 v[156:159], v2, s[8:11], s15 offen offset:1024
    buffer_load_dwordx4 v[160:163], v2, s[8:11], s12 offen offset:2048
    buffer_load_dwordx4 v[164:167], v2, s[8:11], s13 offen offset:2048
    buffer_load_dwordx4 v[168:171], v2, s[8:11], s14 offen offset:2048
    buffer_load_dwordx4 v[172:175], v2, s[8:11], s15 offen offset:2048
    buffer_load_dwordx4 v[176:179], v2, s[8:11], s12 offen offset:3072
    buffer_load_dwordx4 v[180:183], v2, s[8:11], s13 offen offset:3072
    buffer_load_dwordx4 v[184:187], v2, s[8:11], s14 offen offset:3072
    buffer_load_dwordx4 v[188:191], v2, s[8:11], s15 offen offset:3072
    s_add_u32 s12, s12, 4096
    s_add_u32 s13, s13, 4096
    s_add_u32 s14, s14, 4096
    s_add_u32 s15, s15, 4096
    buffer_load_dwordx4 v[192:195], v2, s[8:11], s12 offen offset:0
    buffer_load_dwordx4 v[196:199], v2, s[8:11], s13 offen offset:0
    buffer_load_dwordx4 v[200:203], v2, s[8:11], s14 offen offset:0
    buffer_load_dwordx4 v[204:207], v2, s[8:11], s15 offen offset:0
    buffer_load_dwordx4 v[208:211], v2, s[8:11], s12 offen offset:1024
    buffer_load_dwordx4 v[212:215], v2, s[8:11], s13 offen offset:1024
    buffer_load_dwordx4 v[216:219], v2, s[8:11], s14 offen offset:1024
    buffer_load_dwordx4 v[220:223], v2, s[8:11], s15 offen offset:1024
    buffer_load_dwordx4 v[224:227], v2, s[8:11], s12 offen offset:2048
    buffer_load_dwordx4 v[228:231], v2, s[8:11], s13 offen offset:2048
    buffer_load_dwordx4 v[232:235], v2, s[8:11], s14 offen offset:2048
    buffer_load_dwordx4 v[236:239], v2, s[8:11], s15 offen offset:2048
    v_lshrrev_b32 v3, 3, v0
    v_and_b32 v4, 7, v0
    s_lshl_b32 s6, s4, 6
    v_add_u32 v5, s6, v3
    s_lshl_b32 s7, s5, 6
    v_lshl_add_u32 v6, v4, 3, s7
    v_mul_u32_u24 v7, 896, v5
    v_lshl_add_u32 v7, v6, 1, v7
    global_load_dwordx4 v[8:11], v7, s[16:17]
    v_lshlrev_b32 v16, 1, v6
    global_load_dwordx4 v[20:23], v16, s[32:33]
    v_lshlrev_b32 v16, 3, v5
    s_mov_b32 s6, 0x548000
    buffer_load_dwordx2 v[28:29], v16, s[8:11], s6 offen
    v_lshlrev_b32 v16, 12, v6
    v_lshl_add_u32 v16, v5, 1, v16
    s_mov_b32 s6, 0x14d4000
    buffer_load_ushort v44, v16, s[8:11], s6 offen
    s_add_u32 s6, s6, 4096
    buffer_load_ushort v45, v16, s[8:11], s6 offen
    s_add_u32 s6, s6, 4096
    buffer_load_ushort v46, v16, s[8:11], s6 offen
    s_add_u32 s6, s6, 4096
    buffer_load_ushort v47, v16, s[8:11], s6 offen
    s_add_u32 s6, s6, 4096
    buffer_load_ushort v48, v16, s[8:11], s6 offen
    s_add_u32 s6, s6, 4096
    buffer_load_ushort v49, v16, s[8:11], s6 offen
    s_add_u32 s6, s6, 4096
    buffer_load_ushort v50, v16, s[8:11], s6 offen
    s_add_u32 s6, s6, 4096
    buffer_load_ushort v51, v16, s[8:11], s6 offen
    s_add_u32 s6, s6, 4096
    buffer_load_dwordx4 v[240:243], v2, s[8:11], s12 offen offset:3072
    buffer_load_dwordx4 v[244:247], v2, s[8:11], s13 offen offset:3072
    buffer_load_dwordx4 v[248:251], v2, s[8:11], s14 offen offset:3072
    buffer_load_dwordx4 v[252:255], v2, s[8:11], s15 offen offset:3072
    s_add_u32 s12, s12, 4096
    s_add_u32 s13, s13, 4096
    s_add_u32 s14, s14, 4096
    s_add_u32 s15, s15, 4096
    s_waitcnt vmcnt(39)
    v_mfma_f32_32x32x16_bf16 v[64:79], v[128:131], v[136:139], 0
    v_mfma_f32_32x32x16_bf16 v[80:95], v[128:131], v[140:143], 0
    v_mfma_f32_32x32x16_bf16 v[96:111], v[132:135], v[136:139], 0
    v_mfma_f32_32x32x16_bf16 v[112:127], v[132:135], v[140:143], 0
    buffer_load_dwordx4 v[128:131], v2, s[8:11], s12 offen offset:0
    buffer_load_dwordx4 v[132:135], v2, s[8:11], s13 offen offset:0
    buffer_load_dwordx4 v[136:139], v2, s[8:11], s14 offen offset:0
    buffer_load_dwordx4 v[140:143], v2, s[8:11], s15 offen offset:0
    s_waitcnt vmcnt(39)
    v_mfma_f32_32x32x16_bf16 v[64:79], v[144:147], v[152:155], v[64:79]
    v_mfma_f32_32x32x16_bf16 v[80:95], v[144:147], v[156:159], v[80:95]
    v_mfma_f32_32x32x16_bf16 v[96:111], v[148:151], v[152:155], v[96:111]
    v_mfma_f32_32x32x16_bf16 v[112:127], v[148:151], v[156:159], v[112:127]
    buffer_load_dwordx4 v[144:147], v2, s[8:11], s12 offen offset:1024
    buffer_load_dwordx4 v[148:151], v2, s[8:11], s13 offen offset:1024
    buffer_load_dwordx4 v[152:155], v2, s[8:11], s14 offen offset:1024
    buffer_load_dwordx4 v[156:159], v2, s[8:11], s15 offen offset:1024
    s_waitcnt vmcnt(39)
    v_mfma_f32_32x32x16_bf16 v[64:79], v[160:163], v[168:171], v[64:79]
    v_mfma_f32_32x32x16_bf16 v[80:95], v[160:163], v[172:175], v[80:95]
    v_mfma_f32_32x32x16_bf16 v[96:111], v[164:167], v[168:171], v[96:111]
    v_mfma_f32_32x32x16_bf16 v[112:127], v[164:167], v[172:175], v[112:127]
    buffer_load_dwordx4 v[160:163], v2, s[8:11], s12 offen offset:2048
    buffer_load_dwordx4 v[164:167], v2, s[8:11], s13 offen offset:2048
    buffer_load_dwordx4 v[168:171], v2, s[8:11], s14 offen offset:2048
    buffer_load_dwordx4 v[172:175], v2, s[8:11], s15 offen offset:2048
    s_waitcnt vmcnt(39)
    v_mfma_f32_32x32x16_bf16 v[64:79], v[176:179], v[184:187], v[64:79]
    v_mfma_f32_32x32x16_bf16 v[80:95], v[176:179], v[188:191], v[80:95]
    v_mfma_f32_32x32x16_bf16 v[96:111], v[180:183], v[184:187], v[96:111]
    v_mfma_f32_32x32x16_bf16 v[112:127], v[180:183], v[188:191], v[112:127]
    buffer_load_dwordx4 v[176:179], v2, s[8:11], s12 offen offset:3072
    buffer_load_dwordx4 v[180:183], v2, s[8:11], s13 offen offset:3072
    buffer_load_dwordx4 v[184:187], v2, s[8:11], s14 offen offset:3072
    buffer_load_dwordx4 v[188:191], v2, s[8:11], s15 offen offset:3072
    s_add_u32 s12, s12, 4096
    s_add_u32 s13, s13, 4096
    s_add_u32 s14, s14, 4096
    s_add_u32 s15, s15, 4096
    s_waitcnt vmcnt(39)
    v_mfma_f32_32x32x16_bf16 v[64:79], v[192:195], v[200:203], v[64:79]
    v_mfma_f32_32x32x16_bf16 v[80:95], v[192:195], v[204:207], v[80:95]
    v_mfma_f32_32x32x16_bf16 v[96:111], v[196:199], v[200:203], v[96:111]
    v_mfma_f32_32x32x16_bf16 v[112:127], v[196:199], v[204:207], v[112:127]
    buffer_load_dwordx4 v[192:195], v2, s[8:11], s12 offen offset:0
    buffer_load_dwordx4 v[196:199], v2, s[8:11], s13 offen offset:0
    buffer_load_dwordx4 v[200:203], v2, s[8:11], s14 offen offset:0
    buffer_load_dwordx4 v[204:207], v2, s[8:11], s15 offen offset:0
    s_waitcnt vmcnt(39)
    v_mfma_f32_32x32x16_bf16 v[64:79], v[208:211], v[216:219], v[64:79]
    v_mfma_f32_32x32x16_bf16 v[80:95], v[208:211], v[220:223], v[80:95]
    v_mfma_f32_32x32x16_bf16 v[96:111], v[212:215], v[216:219], v[96:111]
    v_mfma_f32_32x32x16_bf16 v[112:127], v[212:215], v[220:223], v[112:127]
    buffer_load_dwordx4 v[208:211], v2, s[8:11], s12 offen offset:1024
    buffer_load_dwordx4 v[212:215], v2, s[8:11], s13 offen offset:1024
    buffer_load_dwordx4 v[216:219], v2, s[8:11], s14 offen offset:1024
    buffer_load_dwordx4 v[220:223], v2, s[8:11], s15 offen offset:1024
    s_waitcnt vmcnt(39)
    v_mfma_f32_32x32x16_bf16 v[64:79], v[224:227], v[232:235], v[64:79]
    v_mfma_f32_32x32x16_bf16 v[80:95], v[224:227], v[236:239], v[80:95]
    v_mfma_f32_32x32x16_bf16 v[96:111], v[228:231], v[232:235], v[96:111]
    v_mfma_f32_32x32x16_bf16 v[112:127], v[228:231], v[236:239], v[112:127]
    s_waitcnt vmcnt(24)
    v_mfma_f32_32x32x16_bf16 v[64:79], v[240:243], v[248:251], v[64:79]
    v_mfma_f32_32x32x16_bf16 v[80:95], v[240:243], v[252:255], v[80:95]
    v_mfma_f32_32x32x16_bf16 v[96:111], v[244:247], v[248:251], v[96:111]
    v_mfma_f32_32x32x16_bf16 v[112:127], v[244:247], v[252:255], v[112:127]
    s_waitcnt vmcnt(20)
    v_mfma_f32_32x32x16_bf16 v[64:79], v[128:131], v[136:139], v[64:79]
    v_mfma_f32_32x32x16_bf16 v[80:95], v[128:131], v[140:143], v[80:95]
    v_mfma_f32_32x32x16_bf16 v[96:111], v[132:135], v[136:139], v[96:111]
    v_mfma_f32_32x32x16_bf16 v[112:127], v[132:135], v[140:143], v[112:127]
    s_waitcnt vmcnt(16)
    v_mfma_f32_32x32x16_bf16 v[64:79], v[144:147], v[152:155], v[64:79]
    v_mfma_f32_32x32x16_bf16 v[80:95], v[144:147], v[156:159], v[80:95]
    v_mfma_f32_32x32x16_bf16 v[96:111], v[148:151], v[152:155], v[96:111]
    v_mfma_f32_32x32x16_bf16 v[112:127], v[148:151], v[156:159], v[112:127]
    s_waitcnt vmcnt(12)
    v_mfma_f32_32x32x16_bf16 v[64:79], v[160:163], v[168:171], v[64:79]
    v_mfma_f32_32x32x16_bf16 v[80:95], v[160:163], v[172:175], v[80:95]
    v_mfma_f32_32x32x16_bf16 v[96:111], v[164:167], v[168:171], v[96:111]
    v_mfma_f32_32x32x16_bf16 v[112:127], v[164:167], v[172:175], v[112:127]
    s_waitcnt vmcnt(8)
    v_mfma_f32_32x32x16_bf16 v[64:79], v[176:179], v[184:187], v[64:79]
    v_mfma_f32_32x32x16_bf16 v[80:95], v[176:179], v[188:191], v[80:95]
    v_mfma_f32_32x32x16_bf16 v[96:111], v[180:183], v[184:187], v[96:111]
    v_mfma_f32_32x32x16_bf16 v[112:127], v[180:183], v[188:191], v[112:127]
    s_waitcnt vmcnt(4)
    v_mfma_f32_32x32x16_bf16 v[64:79], v[192:195], v[200:203], v[64:79]
    v_mfma_f32_32x32x16_bf16 v[80:95], v[192:195], v[204:207], v[80:95]
    v_mfma_f32_32x32x16_bf16 v[96:111], v[196:199], v[200:203], v[96:111]
    v_mfma_f32_32x32x16_bf16 v[112:127], v[196:199], v[204:207], v[112:127]
    s_waitcnt vmcnt(0)
    v_mfma_f32_32x32x16_bf16 v[64:79], v[208:211], v[216:219], v[64:79]
    v_mfma_f32_32x32x16_bf16 v[80:95], v[208:211], v[220:223], v[80:95]
    v_mfma_f32_32x32x16_bf16 v[96:111], v[212:215], v[216:219], v[96:111]
    v_mfma_f32_32x32x16_bf16 v[112:127], v[212:215], v[220:223], v[112:127]
    v_and_b32 v40, 31, v1
    v_lshrrev_b32 v41, 5, v1
    v_mul_u32_u24 v40, 272, v40
    v_lshl_add_u32 v40, v41, 4, v40
    s_mul_i32 s6, s3, 17408
    v_add_u32 v40, s6, v40
    s_nop 15
    ds_write_b128 v40, v[64:67] offset:0
    ds_write_b128 v40, v[68:71] offset:32
    ds_write_b128 v40, v[72:75] offset:64
    ds_write_b128 v40, v[76:79] offset:96
    ds_write_b128 v40, v[80:83] offset:8704
    ds_write_b128 v40, v[84:87] offset:8736
    ds_write_b128 v40, v[88:91] offset:8768
    ds_write_b128 v40, v[92:95] offset:8800
    ds_write_b128 v40, v[96:99] offset:128
    ds_write_b128 v40, v[100:103] offset:160
    ds_write_b128 v40, v[104:107] offset:192
    ds_write_b128 v40, v[108:111] offset:224
    ds_write_b128 v40, v[112:115] offset:8832
    ds_write_b128 v40, v[116:119] offset:8864
    ds_write_b128 v40, v[120:123] offset:8896
    ds_write_b128 v40, v[124:127] offset:8928
    v_mul_u32_u24 v41, 272, v3
    v_lshl_add_u32 v41, v4, 5, v41
    v_add_u32 v42, 69632, v41
    s_waitcnt lgkmcnt(0)
    s_barrier
    ds_read_b128 v[64:67], v41 offset:0
    ds_read_b128 v[68:71], v41 offset:16
    ds_read_b128 v[72:75], v41 offset:17408
    ds_read_b128 v[76:79], v41 offset:17424
    ds_read_b128 v[80:83], v41 offset:34816
    ds_read_b128 v[84:87], v41 offset:34832
    ds_read_b128 v[88:91], v41 offset:52224
    ds_read_b128 v[92:95], v41 offset:52240
    s_waitcnt lgkmcnt(4)
    ds_read_b128 v[96:99], v42 offset:0
    ds_read_b128 v[100:103], v42 offset:16
    ds_read_b128 v[104:107], v42 offset:17408
    ds_read_b128 v[108:111], v42 offset:17424
    ds_read_b128 v[112:115], v42 offset:34816
    ds_read_b128 v[116:119], v42 offset:34832
    ds_read_b128 v[120:123], v42 offset:52224
    ds_read_b128 v[124:127], v42 offset:52240
    s_waitcnt lgkmcnt(0)
    v_add_f32 v64, v64, v72
    v_add_f32 v65, v65, v73
    v_add_f32 v66, v66, v74
    v_add_f32 v67, v67, v75
    v_add_f32 v68, v68, v76
    v_add_f32 v69, v69, v77
    v_add_f32 v70, v70, v78
    v_add_f32 v71, v71, v79
    v_add_f32 v80, v80, v88
    v_add_f32 v81, v81, v89
    v_add_f32 v82, v82, v90
    v_add_f32 v83, v83, v91
    v_add_f32 v84, v84, v92
    v_add_f32 v85, v85, v93
    v_add_f32 v86, v86, v94
    v_add_f32 v87, v87, v95
    v_add_f32 v96, v96, v104
    v_add_f32 v97, v97, v105
    v_add_f32 v98, v98, v106
    v_add_f32 v99, v99, v107
    v_add_f32 v100, v100, v108
    v_add_f32 v101, v101, v109
    v_add_f32 v102, v102, v110
    v_add_f32 v103, v103, v111
    v_add_f32 v112, v112, v120
    v_add_f32 v113, v113, v121
    v_add_f32 v114, v114, v122
    v_add_f32 v115, v115, v123
    v_add_f32 v116, v116, v124
    v_add_f32 v117, v117, v125
    v_add_f32 v118, v118, v126
    v_add_f32 v119, v119, v127
    v_add_f32 v64, v64, v80
    v_add_f32 v65, v65, v81
    v_add_f32 v66, v66, v82
    v_add_f32 v67, v67, v83
    v_add_f32 v68, v68, v84
    v_add_f32 v69, v69, v85
    v_add_f32 v70, v70, v86
    v_add_f32 v71, v71, v87
    v_add_f32 v96, v96, v112
    v_add_f32 v97, v97, v113
    v_add_f32 v98, v98, v114
    v_add_f32 v99, v99, v115
    v_add_f32 v100, v100, v116
    v_add_f32 v101, v101, v117
    v_add_f32 v102, v102, v118
    v_add_f32 v103, v103, v119
    v_add_f32 v64, v64, v96
    v_add_f32 v65, v65, v97
    v_add_f32 v66, v66, v98
    v_add_f32 v67, v67, v99
    v_add_f32 v68, v68, v100
    v_add_f32 v69, v69, v101
    v_add_f32 v70, v70, v102
    v_add_f32 v71, v71, v103
    s_waitcnt vmcnt(0)
    v_rcp_f32 v30, v29
    v_lshlrev_b32 v80, 16, v8
    v_and_b32 v88, 0xffff0000, v8
    v_lshlrev_b32 v81, 16, v9
    v_and_b32 v89, 0xffff0000, v9
    v_lshlrev_b32 v82, 16, v10
    v_and_b32 v90, 0xffff0000, v10
    v_lshlrev_b32 v83, 16, v11
    v_and_b32 v91, 0xffff0000, v11
    v_sub_f32 v96, v80, v28
    v_sub_f32 v104, v88, v28
    v_sub_f32 v97, v81, v28
    v_sub_f32 v105, v89, v28
    v_sub_f32 v98, v82, v28
    v_sub_f32 v106, v90, v28
    v_sub_f32 v99, v83, v28
    v_sub_f32 v107, v91, v28
    v_cvt_pk_bf16_f32 v8, v96, v104
    v_cvt_pk_bf16_f32 v9, v97, v105
    v_cvt_pk_bf16_f32 v10, v98, v106
    v_cvt_pk_bf16_f32 v11, v99, v107
    v_lshlrev_b32 v112, 16, v8
    v_and_b32 v120, 0xffff0000, v8
    v_lshlrev_b32 v113, 16, v9
    v_and_b32 v121, 0xffff0000, v9
    v_lshlrev_b32 v114, 16, v10
    v_and_b32 v122, 0xffff0000, v10
    v_lshlrev_b32 v115, 16, v11
    v_and_b32 v123, 0xffff0000, v11
    v_mul_f32 v96, v112, v30
    v_mul_f32 v104, v120, v30
    v_mul_f32 v97, v113, v30
    v_mul_f32 v105, v121, v30
    v_mul_f32 v98, v114, v30
    v_mul_f32 v106, v122, v30
    v_mul_f32 v99, v115, v30
    v_mul_f32 v107, v123, v30
    v_fma_f32 v112, -v96, v29, v112
    v_fma_f32 v120, -v104, v29, v120
    v_fma_f32 v113, -v97, v29, v113
    v_fma_f32 v121, -v105, v29, v121
    v_fma_f32 v114, -v98, v29, v114
    v_fma_f32 v122, -v106, v29, v122
    v_fma_f32 v115, -v99, v29, v115
    v_fma_f32 v123, -v107, v29, v123
    v_fmac_f32 v96, v112, v30
    v_fmac_f32 v104, v120, v30
    v_fmac_f32 v97, v113, v30
    v_fmac_f32 v105, v121, v30
    v_fmac_f32 v98, v114, v30
    v_fmac_f32 v106, v122, v30
    v_fmac_f32 v99, v115, v30
    v_fmac_f32 v107, v123, v30
    v_cvt_pk_bf16_f32 v8, v96, v104
    v_cvt_pk_bf16_f32 v9, v97, v105
    v_cvt_pk_bf16_f32 v10, v98, v106
    v_cvt_pk_bf16_f32 v11, v99, v107
    v_lshlrev_b32 v96, 16, v8
    v_and_b32 v104, 0xffff0000, v8
    v_lshlrev_b32 v112, 16, v20
    v_and_b32 v120, 0xffff0000, v20
    v_lshlrev_b32 v97, 16, v9
    v_and_b32 v105, 0xffff0000, v9
    v_lshlrev_b32 v113, 16, v21
    v_and_b32 v121, 0xffff0000, v21
    v_lshlrev_b32 v98, 16, v10
    v_and_b32 v106, 0xffff0000, v10
    v_lshlrev_b32 v114, 16, v22
    v_and_b32 v122, 0xffff0000, v22
    v_lshlrev_b32 v99, 16, v11
    v_and_b32 v107, 0xffff0000, v11
    v_lshlrev_b32 v115, 16, v23
    v_and_b32 v123, 0xffff0000, v23
    v_mul_f32 v96, v96, v112
    v_mul_f32 v104, v104, v120
    v_mul_f32 v97, v97, v113
    v_mul_f32 v105, v105, v121
    v_mul_f32 v98, v98, v114
    v_mul_f32 v106, v106, v122
    v_mul_f32 v99, v99, v115
    v_mul_f32 v107, v107, v123
    v_cvt_pk_bf16_f32 v8, v96, v104
    v_cvt_pk_bf16_f32 v9, v97, v105
    v_cvt_pk_bf16_f32 v10, v98, v106
    v_cvt_pk_bf16_f32 v11, v99, v107
    v_lshlrev_b32 v96, 16, v8
    v_and_b32 v104, 0xffff0000, v8
    v_lshlrev_b32 v112, 16, v44
    v_lshlrev_b32 v120, 16, v45
    v_lshlrev_b32 v97, 16, v9
    v_and_b32 v105, 0xffff0000, v9
    v_lshlrev_b32 v113, 16, v46
    v_lshlrev_b32 v121, 16, v47
    v_lshlrev_b32 v98, 16, v10
    v_and_b32 v106, 0xffff0000, v10
    v_lshlrev_b32 v114, 16, v48
    v_lshlrev_b32 v122, 16, v49
    v_lshlrev_b32 v99, 16, v11
    v_and_b32 v107, 0xffff0000, v11
    v_lshlrev_b32 v115, 16, v50
    v_lshlrev_b32 v123, 16, v51
    v_add_f32 v96, v96, v112
    v_add_f32 v104, v104, v120
    v_add_f32 v97, v97, v113
    v_add_f32 v105, v105, v121
    v_add_f32 v98, v98, v114
    v_add_f32 v106, v106, v122
    v_add_f32 v99, v99, v115
    v_add_f32 v107, v107, v123
    v_cvt_pk_bf16_f32 v8, v96, v104
    v_cvt_pk_bf16_f32 v9, v97, v105
    v_cvt_pk_bf16_f32 v10, v98, v106
    v_cvt_pk_bf16_f32 v11, v99, v107
    v_lshlrev_b32 v96, 16, v8
    v_and_b32 v104, 0xffff0000, v8
    v_lshlrev_b32 v97, 16, v9
    v_and_b32 v105, 0xffff0000, v9
    v_lshlrev_b32 v98, 16, v10
    v_and_b32 v106, 0xffff0000, v10
    v_lshlrev_b32 v99, 16, v11
    v_and_b32 v107, 0xffff0000, v11
    v_add_f32 v96, v80, v96
    v_add_f32 v104, v88, v104
    v_add_f32 v97, v81, v97
    v_add_f32 v105, v89, v105
    v_add_f32 v98, v82, v98
    v_add_f32 v106, v90, v106
    v_add_f32 v99, v83, v99
    v_add_f32 v107, v91, v107
    v_cvt_pk_bf16_f32 v8, v96, v104
    v_cvt_pk_bf16_f32 v20, v64, v65
    v_cvt_pk_bf16_f32 v9, v97, v105
    v_cvt_pk_bf16_f32 v21, v66, v67
    v_cvt_pk_bf16_f32 v10, v98, v106
    v_cvt_pk_bf16_f32 v22, v68, v69
    v_cvt_pk_bf16_f32 v11, v99, v107
    v_cvt_pk_bf16_f32 v23, v70, v71
    v_lshlrev_b32 v96, 16, v8
    v_and_b32 v104, 0xffff0000, v8
    v_lshlrev_b32 v112, 16, v20
    v_and_b32 v120, 0xffff0000, v20
    v_lshlrev_b32 v97, 16, v9
    v_and_b32 v105, 0xffff0000, v9
    v_lshlrev_b32 v113, 16, v21
    v_and_b32 v121, 0xffff0000, v21
    v_lshlrev_b32 v98, 16, v10
    v_and_b32 v106, 0xffff0000, v10
    v_lshlrev_b32 v114, 16, v22
    v_and_b32 v122, 0xffff0000, v22
    v_lshlrev_b32 v99, 16, v11
    v_and_b32 v107, 0xffff0000, v11
    v_lshlrev_b32 v115, 16, v23
    v_and_b32 v123, 0xffff0000, v23
    v_add_f32 v96, v96, v112
    v_add_f32 v104, v104, v120
    v_add_f32 v97, v97, v113
    v_add_f32 v105, v105, v121
    v_add_f32 v98, v98, v114
    v_add_f32 v106, v106, v122
    v_add_f32 v99, v99, v115
    v_add_f32 v107, v107, v123
    v_cvt_pk_bf16_f32 v8, v96, v104
    v_cvt_pk_bf16_f32 v9, v97, v105
    v_cvt_pk_bf16_f32 v10, v98, v106
    v_cvt_pk_bf16_f32 v11, v99, v107
    global_store_dwordx4 v7, v[8:11], s[42:43]
L_fin_end:
    s_endpgm
.section .rodata,"a"
.p2align 6
.amdhsa_kernel prep_kernel
  .amdhsa_next_free_vgpr 120
  .amdhsa_next_free_sgpr 72
  .amdhsa_accum_offset 120
  .amdhsa_group_segment_fixed_size 0
  .amdhsa_kernarg_size 128
  .amdhsa_user_sgpr_count 2
  .amdhsa_user_sgpr_kernarg_segment_ptr 1
  .amdhsa_system_sgpr_workgroup_id_x 1
.end_amdhsa_kernel

.p2align 6
.amdhsa_kernel mid_kernel
  .amdhsa_next_free_vgpr 128
  .amdhsa_next_free_sgpr 72
  .amdhsa_accum_offset 128
  .amdhsa_group_segment_fixed_size 0
  .amdhsa_kernarg_size 128
  .amdhsa_user_sgpr_count 2
  .amdhsa_user_sgpr_kernarg_segment_ptr 1
  .amdhsa_system_sgpr_workgroup_id_x 1
.end_amdhsa_kernel

.p2align 6
.amdhsa_kernel fin_kernel
  .amdhsa_next_free_vgpr 256
  .amdhsa_next_free_sgpr 72
  .amdhsa_accum_offset 256
  .amdhsa_group_segment_fixed_size 0
  .amdhsa_kernarg_size 128
  .amdhsa_user_sgpr_count 2
  .amdhsa_user_sgpr_kernarg_segment_ptr 1
  .amdhsa_system_sgpr_workgroup_id_x 1
.end_amdhsa_kernel
```
